```python
import torch

def _softmax(x, axis=-1):
    return torch.softmax(x, dim=axis)
def _gelu(x):
    return torch.nn.functional.gelu(x, approximate="tanh")
def _silu(x):
    return torch.nn.functional.silu(x)
def _sigmoid(x):
    return torch.sigmoid(x)
def _layernorm(x, axis=-1, eps=1e-5):
    m = x.mean(dim=axis, keepdim=True)
    v = x.var(dim=axis, keepdim=True, unbiased=False)
    return (x - m) / torch.sqrt(v + eps)
def _scatter_add(tgt, idx, src, axis=0):
    return tgt.clone().index_add_(axis, idx, src)
def _segment_sum(src, seg, n):
    out = torch.zeros((n,) + src.shape[1:], dtype=src.dtype)
    return out.index_add_(0, seg, src)
def _pad(x, pw):
    flat = tuple(v for pair in reversed(pw) for v in pair)
    return torch.nn.functional.pad(x, flat)

kernel_name = 'gather_scatter__hybrid_graph_tf_exphormer__graph'

def setup_inputs():

    _w = (lambda a: (lambda t: t.to(torch.bfloat16) if t.is_floating_point() else t)(torch.as_tensor(a)))
    N, deg, D = 10000, 16, 256
    E = N * deg
    exp_deg = 4
    Ee = N * exp_deg
    src = (lambda lo, hi, *s: torch.randint(lo, hi, s))(0, N, E).to(torch.int64)
    dst = (lambda lo, hi, *s: torch.randint(lo, hi, s))(0, N, E).to(torch.int64)
    esrc = (lambda lo, hi, *s: torch.randint(lo, hi, s))(0, N, Ee).to(torch.int64)
    edst = torch.repeat_interleave(torch.arange(N), exp_deg).to(torch.int64)
    deg_cnt = torch.bincount(dst, minlength=N).to(float) + 1.0
    return {
        "x": _w((lambda *s: torch.randn(*s, dtype=torch.bfloat16) * 0.05)(N, D)),
        "src": _w(src),
        "dst": _w(dst),
        "esrc": _w(esrc),
        "edst": _w(edst),
        "deg_inv_sqrt": _w(1.0 / (lambda _x: torch.sqrt(torch.as_tensor(_x)))(deg_cnt)),
        "w_l": _w((lambda *s: torch.randn(*s, dtype=torch.bfloat16) * 0.05)(D, D)),
        "wq": _w((lambda *s: torch.randn(*s, dtype=torch.bfloat16) * 0.05)(D, D)),
        "wk": _w((lambda *s: torch.randn(*s, dtype=torch.bfloat16) * 0.05)(D, D)),
        "wv": _w((lambda *s: torch.randn(*s, dtype=torch.bfloat16) * 0.05)(D, D)),
    }

def reference(x, src, dst, esrc, edst, deg_inv_sqrt, w_l, wq, wk, wv):
    N, D = x.shape
    h = x @ w_l
    msg = h[src] * deg_inv_sqrt[src, None] * deg_inv_sqrt[dst, None]
    h_local = _segment_sum(msg, dst, N)
    q = x @ wq
    k = x @ wk
    v = x @ wv
    e = (q[edst] * k[esrc]).sum(-1) * (D ** -0.5)
    exp_e = torch.exp(e)
    denom = _segment_sum(exp_e[:, None], edst, N)[:, 0] + 1e-9
    alpha = exp_e / denom[edst]
    h_attn = _segment_sum(alpha[:, None] * v[esrc], edst, N)
    return h_local + h_attn
```

```asm
; @launch grid=(251,1,1) block=(512,1,1) lds=163840
.amdgcn_target "amdgcn-amd-amdhsa--gfx950"
.text
.globl gather_scatter__hybrid_graph_tf_exphormer__graph_kernel
.p2align 8
.type gather_scatter__hybrid_graph_tf_exphormer__graph_kernel,@function
gather_scatter__hybrid_graph_tf_exphormer__graph_kernel:
    s_cmp_gt_u32 s2, 250
    s_cbranch_scc1 L_end
    s_load_dwordx8 s[4:11], s[0:1], 0
    s_load_dwordx2 s[14:15], s[0:1], 40
    s_load_dwordx4 s[16:19], s[0:1], 48
    s_load_dwordx8 s[20:27], s[0:1], 64
    s_load_dwordx2 s[28:29], s[0:1], 96
    v_lshrrev_b32 v4, 6, v0
    v_and_b32 v1, 63, v0
    v_readfirstlane_b32 s3, v4
    v_mov_b32 v2, 0
    v_mov_b32 v3, 1
    s_mov_b32 s93, 0
    v_lshlrev_b32 v4, 2, v1
    s_cmp_eq_u32 s2, 250
    s_cbranch_scc1 L_upd
    ds_write_b32 v4, v2
    s_and_b32 s32, s3, 3
    s_mul_i32 s12, s2, 40
    s_mov_b32 s13, 40
    s_mov_b32 s68, 0x05040100
    s_mov_b32 s69, 0x07060302
    s_cmp_ge_u32 s3, 4
    s_cbranch_scc1 L_A
    s_lshl_b32 s60, s12, 4
    s_mul_i32 s34, s32, 160
    s_add_u32 s60, s60, s34
    v_and_b32 v252, 15, v1
    v_lshrrev_b32 v253, 4, v1
    v_lshlrev_b32 v36, 5, v253
    v_lshlrev_b32 v37, 3, v253
    v_lshrrev_b32 v38, 5, v1
    s_mul_i32 s33, s32, 10
    v_add_u32 v38, s33, v38
    v_and_b32 v39, 31, v1
    s_lshl_b32 s34, s12, 9
    s_mul_i32 s35, s32, 5120
    s_add_u32 s35, s35, 65792
    v_and_b32 v208, 15, v38
    v_xor_b32 v208, v208, v39
    v_lshlrev_b32 v208, 4, v208
    v_lshl_add_u32 v208, v38, 9, v208
    v_add_u32 v38, 2, v38
    v_and_b32 v209, 15, v38
    v_xor_b32 v209, v209, v39
    v_lshlrev_b32 v209, 4, v209
    v_lshl_add_u32 v209, v38, 9, v209
    v_add_u32 v38, 2, v38
    v_and_b32 v210, 15, v38
    v_xor_b32 v210, v210, v39
    v_lshlrev_b32 v210, 4, v210
    v_lshl_add_u32 v210, v38, 9, v210
    v_add_u32 v38, 2, v38
    v_and_b32 v211, 15, v38
    v_xor_b32 v211, v211, v39
    v_lshlrev_b32 v211, 4, v211
    v_lshl_add_u32 v211, v38, 9, v211
    v_add_u32 v38, 2, v38
    v_and_b32 v212, 15, v38
    v_xor_b32 v212, v212, v39
    v_lshlrev_b32 v212, 4, v212
    v_lshl_add_u32 v212, v38, 9, v212
    v_add_u32 v38, 2, v38
    s_waitcnt lgkmcnt(0)
    s_mov_b32 s36, s4
    s_mov_b32 s37, s5
    s_mov_b32 s38, 5120000
    s_mov_b32 s39, 0x20000
    s_mov_b32 s56, s10
    s_mov_b32 s57, s11
    s_mov_b32 s58, 160000
    s_mov_b32 s59, 0x20000
    buffer_load_dwordx4 v[52:55], v36, s[56:59], s60 offen
    buffer_load_dwordx4 v[56:59], v36, s[56:59], s60 offen offset:16
    buffer_load_dwordx2 v[60:61], v37, s[56:59], s60 offen offset:128
    s_add_u32 m0, s35, 0
    s_nop 0
    buffer_load_dwordx4 v208, s[36:39], s34 offen lds
    s_add_u32 m0, s35, 1024
    s_nop 0
    buffer_load_dwordx4 v209, s[36:39], s34 offen lds
    s_add_u32 m0, s35, 2048
    s_nop 0
    buffer_load_dwordx4 v210, s[36:39], s34 offen lds
    s_add_u32 m0, s35, 3072
    s_nop 0
    buffer_load_dwordx4 v211, s[36:39], s34 offen lds
    s_add_u32 m0, s35, 4096
    s_nop 0
    buffer_load_dwordx4 v212, s[36:39], s34 offen lds
    s_mov_b32 s40, s24
    s_mov_b32 s41, s25
    s_mov_b32 s42, 5120000
    s_mov_b32 s43, 0x20000
    s_lshr_b32 s66, s2, 3
    s_and_b32 s66, s66, 31
    s_lshl_b32 s66, s66, 2
    s_add_u32 s66, s66, s32
    v_and_b32 v36, 7, v1
    s_lshl_b32 s33, s66, 3
    v_add_u32 v36, s33, v36
    v_lshlrev_b32 v36, 7, v36
    v_lshrrev_b32 v37, 2, v36
    v_and_b32 v38, 1, v1
    v_lshl_add_u32 v37, v38, 7, v37
    v_min_u32 v37, 19968, v37
    v_and_b32 v37, 0xffffff80, v37
    v_cmp_gt_u32 vcc, 32, v1
    v_mov_b32 v38, s14
    v_mov_b32 v39, s15
    v_cndmask_b32_e64 v36, v37, v36, vcc
    s_mov_b32 exec_hi, 0
    s_mov_b32 exec_lo, 0xff
    v_mov_b32 v38, s18
    v_mov_b32 v39, s19
    s_mov_b32 exec_lo, 0xff00
    v_mov_b32 v38, s20
    v_mov_b32 v39, s21
    s_mov_b32 exec_lo, 0xff0000
    v_mov_b32 v38, s22
    v_mov_b32 v39, s23
    s_mov_b32 exec_lo, 0xff000000
    v_mov_b32 v38, s16
    v_mov_b32 v39, s17
    s_mov_b64 exec, -1
    v_add_co_u32 v38, vcc, v38, v36
    s_nop 1
    v_addc_co_u32 v39, vcc, 0, v39, vcc
    s_mov_b32 exec_hi, 3
    global_load_dword v63, v[38:39], off
    s_mov_b64 exec, -1
    s_cmp_ge_u32 s2, 64
    s_cbranch_scc1 L_b0g
    v_mov_b32 v64, 1032192
    v_mov_b32 v65, 1032192
    v_mov_b32 v66, 1032192
    v_mov_b32 v67, 1032192
    v_lshl_add_u32 v68, s3, 6, v1
    v_lshlrev_b32 v68, 4, v68
    v_add_u32 v68, 131072, v68
    ds_write_b128 v68, v[64:67] offset:0
    ds_write_b128 v68, v[64:67] offset:8192
    ds_write_b128 v68, v[64:67] offset:16384
    ds_write_b128 v68, v[64:67] offset:24576
L_b0g:
    s_waitcnt lgkmcnt(0)
    s_barrier
    v_lshrrev_b32 v36, 3, v1
    v_and_b32 v38, 7, v1
    v_and_b32 v39, 2, v36
    v_xor_b32 v39, v39, v38
    v_lshlrev_b32 v40, 9, v36
    s_lshl_b32 s33, s32, 7
    v_add_u32 v40, s33, v40
    v_lshl_add_u32 v16, v39, 4, v40
    v_xor_b32 v39, 4, v39
    v_lshl_add_u32 v17, v39, 4, v40
    v_add_u32 v18, 30720, v16
    v_add_u32 v19, 46080, v17
    v_add_u32 v17, 15360, v17
    s_lshl_b32 s64, s32, 14
    s_add_u32 s64, s64, 256
    s_mov_b32 s52, s18
    s_mov_b32 s53, s19
    s_mov_b32 s54, 131072
    s_mov_b32 s55, 0x20000
    s_mov_b32 s60, 0
    s_mov_b32 s61, 4096
    s_mov_b32 s62, 8192
    s_mov_b32 s63, 12288
    s_add_u32 m0, s64, 0
    s_nop 0
    buffer_load_dwordx4 v16, s[52:55], s60 offen offset:0  lds
    buffer_load_dwordx4 v17, s[52:55], s60 offen offset:1024  lds
    buffer_load_dwordx4 v18, s[52:55], s60 offen offset:2048  lds
    buffer_load_dwordx4 v19, s[52:55], s60 offen offset:3072  lds
    s_add_u32 m0, s64, 4096
    s_nop 0
    buffer_load_dwordx4 v16, s[52:55], s61 offen offset:0  lds
    buffer_load_dwordx4 v17, s[52:55], s61 offen offset:1024  lds
    buffer_load_dwordx4 v18, s[52:55], s61 offen offset:2048  lds
    buffer_load_dwordx4 v19, s[52:55], s61 offen offset:3072  lds
L_G_s1:
    v_lshlrev_b32 v4, 4, v252
    v_bfe_u32 v36, v1, 2, 2
    v_and_b32 v38, 3, v1
    v_lshlrev_b32 v39, 10, v253
    v_lshl_add_u32 v39, v36, 7, v39
    v_lshl_add_u32 v39, v38, 3, v39
    v_add_u32 v39, s64, v39
    v_and_b32 v40, 1, v253
    v_lshlrev_b32 v40, 1, v40
    v_lshrrev_b32 v36, 1, v36
    v_or_b32 v40, v40, v36
    v_xor_b32 v36, 0, v40
    v_lshl_add_u32 v20, v36, 5, v39
    v_xor_b32 v36, 1, v40
    v_lshl_add_u32 v21, v36, 5, v39
    v_xor_b32 v36, 2, v40
    v_lshl_add_u32 v22, v36, 5, v39
    v_xor_b32 v36, 3, v40
    v_lshl_add_u32 v23, v36, 5, v39
    v_lshlrev_b32 v36, 9, v252
    v_add_u32 v36, 65792, v36
    v_lshlrev_b32 v39, 2, v253
    v_xor_b32 v39, v39, v252
    v_xor_b32 v40, 0, v39
    v_lshl_add_u32 v28, v40, 4, v36
    v_xor_b32 v40, 1, v39
    v_lshl_add_u32 v29, v40, 4, v36
    v_xor_b32 v40, 2, v39
    v_lshl_add_u32 v30, v40, 4, v36
    v_xor_b32 v40, 3, v39
    v_lshl_add_u32 v31, v40, 4, v36
    s_waitcnt vmcnt(9)
    s_mov_b64 exec, 1
    ds_add_u32 v2, v3 offset:0
    s_mov_b64 exec, -1
L_G_j:
    v_lshl_add_u32 v52, v52, 9, v4
    v_lshl_add_u32 v53, v53, 9, v4
    v_lshl_add_u32 v54, v54, 9, v4
    v_lshl_add_u32 v55, v55, 9, v4
    v_lshl_add_u32 v56, v56, 9, v4
    v_lshl_add_u32 v57, v57, 9, v4
    v_lshl_add_u32 v58, v58, 9, v4
    v_lshl_add_u32 v59, v59, 9, v4
    v_lshl_add_u32 v60, v60, 9, v4
    v_lshl_add_u32 v61, v61, 9, v4
    s_add_u32 m0, s64, 8192
    s_nop 0
    buffer_load_dwordx4 v16, s[52:55], s62 offen offset:0  lds
    buffer_load_dwordx4 v17, s[52:55], s62 offen offset:1024  lds
    buffer_load_dwordx4 v18, s[52:55], s62 offen offset:2048  lds
    buffer_load_dwordx4 v19, s[52:55], s62 offen offset:3072  lds
    buffer_load_dwordx4 v[128:131], v52, s[36:39], 0 offen
    buffer_load_dwordx4 v[160:163], v52, s[36:39], 0 offen offset:256
    buffer_load_dwordx4 v[132:135], v53, s[36:39], 0 offen
    buffer_load_dwordx4 v[164:167], v53, s[36:39], 0 offen offset:256
    buffer_load_dwordx4 v[136:139], v54, s[36:39], 0 offen
    buffer_load_dwordx4 v[168:171], v54, s[36:39], 0 offen offset:256
L_sw_1:
    ds_read_b32 v36, v2 offset:0
    s_waitcnt lgkmcnt(0)
    v_readfirstlane_b32 s33, v36
    s_cmp_ge_u32 s33, 4
    s_cbranch_scc1 L_sd_2
    s_add_u32 s93, s93, 1
    s_cmp_lt_u32 s93, 2097152
    s_cbranch_scc1 L_sw_1
    s_endpgm
L_sd_2:
    s_waitcnt vmcnt(14)
    ds_read_b64_tr_b16 v[208:209], v20 offset:0
    ds_read_b64_tr_b16 v[210:211], v20 offset:512
    ds_read_b64_tr_b16 v[212:213], v21 offset:0
    ds_read_b64_tr_b16 v[214:215], v21 offset:512
    ds_read_b64_tr_b16 v[216:217], v22 offset:0
    ds_read_b64_tr_b16 v[218:219], v22 offset:512
    ds_read_b64_tr_b16 v[220:221], v23 offset:0
    ds_read_b64_tr_b16 v[222:223], v23 offset:512
    ds_read_b128 v[240:243], v28 offset:0
    ds_read_b128 v[244:247], v28 offset:8192
    ds_read_b128 v[248:251], v28 offset:16384
    s_waitcnt vmcnt(10)
    ds_read_b64_tr_b16 v[224:225], v20 offset:4096
    ds_read_b64_tr_b16 v[226:227], v20 offset:4608
    ds_read_b64_tr_b16 v[228:229], v21 offset:4096
    ds_read_b64_tr_b16 v[230:231], v21 offset:4608
    ds_read_b64_tr_b16 v[232:233], v22 offset:4096
    ds_read_b64_tr_b16 v[234:235], v22 offset:4608
    ds_read_b64_tr_b16 v[236:237], v23 offset:4096
    ds_read_b64_tr_b16 v[238:239], v23 offset:4608
    ds_read_b128 v[112:115], v29 offset:0
    ds_read_b128 v[116:119], v29 offset:8192
    ds_read_b128 v[120:123], v29 offset:16384
    s_waitcnt lgkmcnt(11)
    s_add_u32 m0, s64, 12288
    s_nop 0
    buffer_load_dwordx4 v16, s[52:55], s63 offen offset:0  lds
    buffer_load_dwordx4 v17, s[52:55], s63 offen offset:1024  lds
    buffer_load_dwordx4 v18, s[52:55], s63 offen offset:2048  lds
    buffer_load_dwordx4 v19, s[52:55], s63 offen offset:3072  lds
    s_mov_b32 s60, 65536
    s_add_u32 m0, s64, 0
    s_nop 0
    buffer_load_dwordx4 v16, s[52:55], s60 offen offset:0  lds
    buffer_load_dwordx4 v17, s[52:55], s60 offen offset:1024  lds
    buffer_load_dwordx4 v18, s[52:55], s60 offen offset:2048  lds
    buffer_load_dwordx4 v19, s[52:55], s60 offen offset:3072  lds
    v_mfma_f32_16x16x32_bf16 v[64:67], v[208:211], v[240:243], 0
    v_mfma_f32_16x16x32_bf16 v[68:71], v[208:211], v[244:247], 0
    v_mfma_f32_16x16x32_bf16 v[72:75], v[208:211], v[248:251], 0
    v_mfma_f32_16x16x32_bf16 v[76:79], v[212:215], v[240:243], 0
    v_mfma_f32_16x16x32_bf16 v[80:83], v[212:215], v[244:247], 0
    v_mfma_f32_16x16x32_bf16 v[84:87], v[212:215], v[248:251], 0
    v_mfma_f32_16x16x32_bf16 v[88:91], v[216:219], v[240:243], 0
    v_mfma_f32_16x16x32_bf16 v[92:95], v[216:219], v[244:247], 0
    v_mfma_f32_16x16x32_bf16 v[96:99], v[216:219], v[248:251], 0
    v_mfma_f32_16x16x32_bf16 v[100:103], v[220:223], v[240:243], 0
    v_mfma_f32_16x16x32_bf16 v[104:107], v[220:223], v[244:247], 0
    v_mfma_f32_16x16x32_bf16 v[108:111], v[220:223], v[248:251], 0
    s_waitcnt vmcnt(14)
    ds_read_b64_tr_b16 v[208:209], v20 offset:8192
    ds_read_b64_tr_b16 v[210:211], v20 offset:8704
    ds_read_b64_tr_b16 v[212:213], v21 offset:8192
    ds_read_b64_tr_b16 v[214:215], v21 offset:8704
    ds_read_b64_tr_b16 v[216:217], v22 offset:8192
    ds_read_b64_tr_b16 v[218:219], v22 offset:8704
    ds_read_b64_tr_b16 v[220:221], v23 offset:8192
    ds_read_b64_tr_b16 v[222:223], v23 offset:8704
    ds_read_b128 v[240:243], v30 offset:0
    ds_read_b128 v[244:247], v30 offset:8192
    ds_read_b128 v[248:251], v30 offset:16384
    s_waitcnt lgkmcnt(11)
    s_mov_b32 s61, 69632
    s_add_u32 m0, s64, 4096
    s_nop 0
    buffer_load_dwordx4 v16, s[52:55], s61 offen offset:0  lds
    buffer_load_dwordx4 v17, s[52:55], s61 offen offset:1024  lds
    buffer_load_dwordx4 v18, s[52:55], s61 offen offset:2048  lds
    buffer_load_dwordx4 v19, s[52:55], s61 offen offset:3072  lds
    v_mfma_f32_16x16x32_bf16 v[64:67], v[224:227], v[112:115], v[64:67]
    v_mfma_f32_16x16x32_bf16 v[68:71], v[224:227], v[116:119], v[68:71]
    v_mfma_f32_16x16x32_bf16 v[72:75], v[224:227], v[120:123], v[72:75]
    v_mfma_f32_16x16x32_bf16 v[76:79], v[228:231], v[112:115], v[76:79]
    v_mfma_f32_16x16x32_bf16 v[80:83], v[228:231], v[116:119], v[80:83]
    v_mfma_f32_16x16x32_bf16 v[84:87], v[228:231], v[120:123], v[84:87]
    v_mfma_f32_16x16x32_bf16 v[88:91], v[232:235], v[112:115], v[88:91]
    v_mfma_f32_16x16x32_bf16 v[92:95], v[232:235], v[116:119], v[92:95]
    v_mfma_f32_16x16x32_bf16 v[96:99], v[232:235], v[120:123], v[96:99]
    v_mfma_f32_16x16x32_bf16 v[100:103], v[236:239], v[112:115], v[100:103]
    v_mfma_f32_16x16x32_bf16 v[104:107], v[236:239], v[116:119], v[104:107]
    v_mfma_f32_16x16x32_bf16 v[108:111], v[236:239], v[120:123], v[108:111]
    s_waitcnt vmcnt(8)
    ds_read_b64_tr_b16 v[224:225], v20 offset:12288
    ds_read_b64_tr_b16 v[226:227], v20 offset:12800
    ds_read_b64_tr_b16 v[228:229], v21 offset:12288
    ds_read_b64_tr_b16 v[230:231], v21 offset:12800
    ds_read_b64_tr_b16 v[232:233], v22 offset:12288
    ds_read_b64_tr_b16 v[234:235], v22 offset:12800
    ds_read_b64_tr_b16 v[236:237], v23 offset:12288
    ds_read_b64_tr_b16 v[238:239], v23 offset:12800
    ds_read_b128 v[112:115], v31 offset:0
    ds_read_b128 v[116:119], v31 offset:8192
    ds_read_b128 v[120:123], v31 offset:16384
    s_waitcnt lgkmcnt(11)
    s_mov_b32 s62, 73728
    s_add_u32 m0, s64, 8192
    s_nop 0
    buffer_load_dwordx4 v16, s[52:55], s62 offen offset:0  lds
    buffer_load_dwordx4 v17, s[52:55], s62 offen offset:1024  lds
    buffer_load_dwordx4 v18, s[52:55], s62 offen offset:2048  lds
    buffer_load_dwordx4 v19, s[52:55], s62 offen offset:3072  lds
    v_mfma_f32_16x16x32_bf16 v[64:67], v[208:211], v[240:243], v[64:67]
    v_mfma_f32_16x16x32_bf16 v[68:71], v[208:211], v[244:247], v[68:71]
    v_mfma_f32_16x16x32_bf16 v[72:75], v[208:211], v[248:251], v[72:75]
    v_mfma_f32_16x16x32_bf16 v[76:79], v[212:215], v[240:243], v[76:79]
    v_mfma_f32_16x16x32_bf16 v[80:83], v[212:215], v[244:247], v[80:83]
    v_mfma_f32_16x16x32_bf16 v[84:87], v[212:215], v[248:251], v[84:87]
    v_mfma_f32_16x16x32_bf16 v[88:91], v[216:219], v[240:243], v[88:91]
    v_mfma_f32_16x16x32_bf16 v[92:95], v[216:219], v[244:247], v[92:95]
    v_mfma_f32_16x16x32_bf16 v[96:99], v[216:219], v[248:251], v[96:99]
    v_mfma_f32_16x16x32_bf16 v[100:103], v[220:223], v[240:243], v[100:103]
    v_mfma_f32_16x16x32_bf16 v[104:107], v[220:223], v[244:247], v[104:107]
    v_mfma_f32_16x16x32_bf16 v[108:111], v[220:223], v[248:251], v[108:111]
    v_lshrrev_b32 v36, 3, v1
    v_and_b32 v38, 7, v1
    v_lshrrev_b32 v39, 1, v36
    v_xor_b32 v39, v39, v38
    s_lshl_b32 s33, s32, 15
    v_lshlrev_b32 v40, 9, v36
    v_add_u32 v40, s33, v40
    v_lshl_add_u32 v12, v39, 4, v40
    v_xor_b32 v39, 4, v39
    v_lshl_add_u32 v13, v39, 4, v40
    v_add_u32 v14, 6144, v12
    v_add_u32 v15, 9216, v13
    v_add_u32 v13, 3072, v13
    v_and_b32 v38, 7, v252
    v_lshlrev_b32 v39, 4, v252
    v_lshl_add_u32 v24, v253, 8, v39
    v_add_u32 v24, 86272, v24
    v_lshlrev_b32 v39, 4, v38
    v_lshl_add_u32 v25, v253, 7, v39
    v_add_u32 v25, 88320, v25
    v_lshrrev_b32 v40, 1, v253
    v_and_b32 v41, 1, v253
    v_lshlrev_b32 v41, 3, v41
    s_mul_i32 s33, s32, 5120
    s_add_u32 s33, s33, 86272
    v_lshl_add_u32 v42, v252, 4, v41
    v_lshl_add_u32 v42, v40, 8, v42
    v_add_u32 v34, s33, v42
    v_add_u32 v42, v39, v41
    v_lshl_add_u32 v42, v40, 7, v42
    s_add_u32 s33, s33, 2048
    v_add_u32 v35, s33, v42
    v_lshrrev_b32 v36, 3, v252
    v_lshlrev_b32 v36, 10, v36
    v_lshl_add_u32 v36, v38, 7, v36
    v_add_u32 v36, s64, v36
    v_lshrrev_b32 v39, 1, v252
    v_xor_b32 v39, v39, v253
    v_lshl_add_u32 v26, v39, 4, v36
    v_xor_b32 v39, 4, v39
    v_lshl_add_u32 v27, v39, 4, v36
    s_waitcnt vmcnt(8)
    ds_read_b64_tr_b16 v[208:209], v20 offset:0
    ds_read_b64_tr_b16 v[210:211], v20 offset:512
    ds_read_b64_tr_b16 v[212:213], v21 offset:0
    ds_read_b64_tr_b16 v[214:215], v21 offset:512
    ds_read_b64_tr_b16 v[216:217], v22 offset:0
    ds_read_b64_tr_b16 v[218:219], v22 offset:512
    ds_read_b64_tr_b16 v[220:221], v23 offset:0
    ds_read_b64_tr_b16 v[222:223], v23 offset:512
    ds_read_b128 v[240:243], v28 offset:256
    ds_read_b128 v[244:247], v28 offset:8448
    ds_read_b128 v[248:251], v28 offset:16640
    s_waitcnt lgkmcnt(11)
    s_mov_b32 s63, 77824
    s_add_u32 m0, s64, 12288
    s_nop 0
    buffer_load_dwordx4 v16, s[52:55], s63 offen offset:0  lds
    buffer_load_dwordx4 v17, s[52:55], s63 offen offset:1024  lds
    buffer_load_dwordx4 v18, s[52:55], s63 offen offset:2048  lds
    buffer_load_dwordx4 v19, s[52:55], s63 offen offset:3072  lds
    v_mfma_f32_16x16x32_bf16 v[64:67], v[224:227], v[112:115], v[64:67]
    v_mfma_f32_16x16x32_bf16 v[68:71], v[224:227], v[116:119], v[68:71]
    v_mfma_f32_16x16x32_bf16 v[72:75], v[224:227], v[120:123], v[72:75]
    v_mfma_f32_16x16x32_bf16 v[76:79], v[228:231], v[112:115], v[76:79]
    v_mfma_f32_16x16x32_bf16 v[80:83], v[228:231], v[116:119], v[80:83]
    v_mfma_f32_16x16x32_bf16 v[84:87], v[228:231], v[120:123], v[84:87]
    v_mfma_f32_16x16x32_bf16 v[88:91], v[232:235], v[112:115], v[88:91]
    v_mfma_f32_16x16x32_bf16 v[92:95], v[232:235], v[116:119], v[92:95]
    v_mfma_f32_16x16x32_bf16 v[96:99], v[232:235], v[120:123], v[96:99]
    v_mfma_f32_16x16x32_bf16 v[100:103], v[236:239], v[112:115], v[100:103]
    v_mfma_f32_16x16x32_bf16 v[104:107], v[236:239], v[116:119], v[104:107]
    v_mfma_f32_16x16x32_bf16 v[108:111], v[236:239], v[120:123], v[108:111]
    s_waitcnt vmcnt(8)
    ds_read_b64_tr_b16 v[224:225], v20 offset:4096
    ds_read_b64_tr_b16 v[226:227], v20 offset:4608
    ds_read_b64_tr_b16 v[228:229], v21 offset:4096
    ds_read_b64_tr_b16 v[230:231], v21 offset:4608
    ds_read_b64_tr_b16 v[232:233], v22 offset:4096
    ds_read_b64_tr_b16 v[234:235], v22 offset:4608
    ds_read_b64_tr_b16 v[236:237], v23 offset:4096
    ds_read_b64_tr_b16 v[238:239], v23 offset:4608
    ds_read_b128 v[112:115], v29 offset:256
    ds_read_b128 v[116:119], v29 offset:8448
    ds_read_b128 v[120:123], v29 offset:16640
    s_waitcnt lgkmcnt(11)
    s_mov_b32 s52, s20
    s_mov_b32 s53, s21
    s_mov_b32 s60, 0
    s_add_u32 m0, s64, 0
    s_nop 0
    buffer_load_dwordx4 v12, s[52:55], s60 offen offset:0  lds
    buffer_load_dwordx4 v13, s[52:55], s60 offen offset:1024  lds
    buffer_load_dwordx4 v14, s[52:55], s60 offen offset:2048  lds
    buffer_load_dwordx4 v15, s[52:55], s60 offen offset:3072  lds
    v_mfma_f32_16x16x32_bf16 v[64:67], v[208:211], v[240:243], v[64:67]
    v_mfma_f32_16x16x32_bf16 v[68:71], v[208:211], v[244:247], v[68:71]
    v_mfma_f32_16x16x32_bf16 v[72:75], v[208:211], v[248:251], v[72:75]
    v_mfma_f32_16x16x32_bf16 v[76:79], v[212:215], v[240:243], v[76:79]
    v_mfma_f32_16x16x32_bf16 v[80:83], v[212:215], v[244:247], v[80:83]
    v_mfma_f32_16x16x32_bf16 v[84:87], v[212:215], v[248:251], v[84:87]
    v_mfma_f32_16x16x32_bf16 v[88:91], v[216:219], v[240:243], v[88:91]
    v_mfma_f32_16x16x32_bf16 v[92:95], v[216:219], v[244:247], v[92:95]
    v_mfma_f32_16x16x32_bf16 v[96:99], v[216:219], v[248:251], v[96:99]
    v_mfma_f32_16x16x32_bf16 v[100:103], v[220:223], v[240:243], v[100:103]
    v_mfma_f32_16x16x32_bf16 v[104:107], v[220:223], v[244:247], v[104:107]
    v_mfma_f32_16x16x32_bf16 v[108:111], v[220:223], v[248:251], v[108:111]
    s_waitcnt vmcnt(8)
    ds_read_b64_tr_b16 v[208:209], v20 offset:8192
    ds_read_b64_tr_b16 v[210:211], v20 offset:8704
    ds_read_b64_tr_b16 v[212:213], v21 offset:8192
    ds_read_b64_tr_b16 v[214:215], v21 offset:8704
    ds_read_b64_tr_b16 v[216:217], v22 offset:8192
    ds_read_b64_tr_b16 v[218:219], v22 offset:8704
    ds_read_b64_tr_b16 v[220:221], v23 offset:8192
    ds_read_b64_tr_b16 v[222:223], v23 offset:8704
    ds_read_b128 v[240:243], v30 offset:256
    ds_read_b128 v[244:247], v30 offset:8448
    ds_read_b128 v[248:251], v30 offset:16640
    s_waitcnt lgkmcnt(11)
    s_mov_b64 exec, 1
    ds_add_u32 v2, v3 offset:60
    s_mov_b64 exec, -1
    s_mov_b32 s61, 16384
    s_add_u32 m0, s64, 4096
    s_nop 0
    buffer_load_dwordx4 v12, s[52:55], s61 offen offset:0  lds
    buffer_load_dwordx4 v13, s[52:55], s61 offen offset:1024  lds
    buffer_load_dwordx4 v14, s[52:55], s61 offen offset:2048  lds
    buffer_load_dwordx4 v15, s[52:55], s61 offen offset:3072  lds
    v_mfma_f32_16x16x32_bf16 v[64:67], v[224:227], v[112:115], v[64:67]
    v_mfma_f32_16x16x32_bf16 v[68:71], v[224:227], v[116:119], v[68:71]
    v_mfma_f32_16x16x32_bf16 v[72:75], v[224:227], v[120:123], v[72:75]
    v_mfma_f32_16x16x32_bf16 v[76:79], v[228:231], v[112:115], v[76:79]
    v_mfma_f32_16x16x32_bf16 v[80:83], v[228:231], v[116:119], v[80:83]
    v_mfma_f32_16x16x32_bf16 v[84:87], v[228:231], v[120:123], v[84:87]
    v_mfma_f32_16x16x32_bf16 v[88:91], v[232:235], v[112:115], v[88:91]
    v_mfma_f32_16x16x32_bf16 v[92:95], v[232:235], v[116:119], v[92:95]
    v_mfma_f32_16x16x32_bf16 v[96:99], v[232:235], v[120:123], v[96:99]
    v_mfma_f32_16x16x32_bf16 v[100:103], v[236:239], v[112:115], v[100:103]
    v_mfma_f32_16x16x32_bf16 v[104:107], v[236:239], v[116:119], v[104:107]
    v_mfma_f32_16x16x32_bf16 v[108:111], v[236:239], v[120:123], v[108:111]
    s_waitcnt vmcnt(8)
    ds_read_b64_tr_b16 v[224:225], v20 offset:12288
    ds_read_b64_tr_b16 v[226:227], v20 offset:12800
    ds_read_b64_tr_b16 v[228:229], v21 offset:12288
    ds_read_b64_tr_b16 v[230:231], v21 offset:12800
    ds_read_b64_tr_b16 v[232:233], v22 offset:12288
    ds_read_b64_tr_b16 v[234:235], v22 offset:12800
    ds_read_b64_tr_b16 v[236:237], v23 offset:12288
    ds_read_b64_tr_b16 v[238:239], v23 offset:12800
    ds_read_b128 v[112:115], v31 offset:256
    ds_read_b128 v[116:119], v31 offset:8448
    ds_read_b128 v[120:123], v31 offset:16640
    s_waitcnt lgkmcnt(12)
    s_mov_b32 s62, 128
    s_add_u32 m0, s64, 8192
    s_nop 0
    buffer_load_dwordx4 v12, s[52:55], s62 offen offset:0  lds
    buffer_load_dwordx4 v13, s[52:55], s62 offen offset:1024  lds
    buffer_load_dwordx4 v14, s[52:55], s62 offen offset:2048  lds
    buffer_load_dwordx4 v15, s[52:55], s62 offen offset:3072  lds
    v_mfma_f32_16x16x32_bf16 v[64:67], v[208:211], v[240:243], v[64:67]
    v_mfma_f32_16x16x32_bf16 v[68:71], v[208:211], v[244:247], v[68:71]
    v_mfma_f32_16x16x32_bf16 v[72:75], v[208:211], v[248:251], v[72:75]
    v_mfma_f32_16x16x32_bf16 v[76:79], v[212:215], v[240:243], v[76:79]
    v_mfma_f32_16x16x32_bf16 v[80:83], v[212:215], v[244:247], v[80:83]
    v_mfma_f32_16x16x32_bf16 v[84:87], v[212:215], v[248:251], v[84:87]
    v_mfma_f32_16x16x32_bf16 v[88:91], v[216:219], v[240:243], v[88:91]
    v_mfma_f32_16x16x32_bf16 v[92:95], v[216:219], v[244:247], v[92:95]
    v_mfma_f32_16x16x32_bf16 v[96:99], v[216:219], v[248:251], v[96:99]
    v_mfma_f32_16x16x32_bf16 v[100:103], v[220:223], v[240:243], v[100:103]
    v_mfma_f32_16x16x32_bf16 v[104:107], v[220:223], v[244:247], v[104:107]
    v_mfma_f32_16x16x32_bf16 v[108:111], v[220:223], v[248:251], v[108:111]
    s_waitcnt lgkmcnt(0)
    s_mov_b32 s63, 16512
    s_add_u32 m0, s64, 12288
    s_nop 0
    buffer_load_dwordx4 v12, s[52:55], s63 offen offset:0  lds
    buffer_load_dwordx4 v13, s[52:55], s63 offen offset:1024  lds
    buffer_load_dwordx4 v14, s[52:55], s63 offen offset:2048  lds
    buffer_load_dwordx4 v15, s[52:55], s63 offen offset:3072  lds
    v_mfma_f32_16x16x32_bf16 v[64:67], v[224:227], v[112:115], v[64:67]
    v_mfma_f32_16x16x32_bf16 v[68:71], v[224:227], v[116:119], v[68:71]
    v_mfma_f32_16x16x32_bf16 v[72:75], v[224:227], v[120:123], v[72:75]
    v_mfma_f32_16x16x32_bf16 v[76:79], v[228:231], v[112:115], v[76:79]
    v_mfma_f32_16x16x32_bf16 v[80:83], v[228:231], v[116:119], v[80:83]
    v_mfma_f32_16x16x32_bf16 v[84:87], v[228:231], v[120:123], v[84:87]
    v_mfma_f32_16x16x32_bf16 v[88:91], v[232:235], v[112:115], v[88:91]
    v_mfma_f32_16x16x32_bf16 v[92:95], v[232:235], v[116:119], v[92:95]
    v_mfma_f32_16x16x32_bf16 v[96:99], v[232:235], v[120:123], v[96:99]
    v_mfma_f32_16x16x32_bf16 v[100:103], v[236:239], v[112:115], v[100:103]
    v_mfma_f32_16x16x32_bf16 v[104:107], v[236:239], v[116:119], v[104:107]
    v_mfma_f32_16x16x32_bf16 v[108:111], v[236:239], v[120:123], v[108:111]
    v_cvt_pk_bf16_f32 v36, v64, v65
    v_cvt_pk_bf16_f32 v37, v66, v67
    ds_write_b64 v34, v[36:37] offset:0
    v_cvt_pk_bf16_f32 v38, v76, v77
    v_cvt_pk_bf16_f32 v39, v78, v79
    ds_write_b64 v34, v[38:39] offset:512
    v_cvt_pk_bf16_f32 v40, v88, v89
    v_cvt_pk_bf16_f32 v41, v90, v91
    ds_write_b64 v34, v[40:41] offset:2560
    v_cvt_pk_bf16_f32 v42, v100, v101
    v_cvt_pk_bf16_f32 v43, v102, v103
    ds_write_b64 v34, v[42:43] offset:3072
    v_cvt_pk_bf16_f32 v36, v68, v69
    v_cvt_pk_bf16_f32 v37, v70, v71
    ds_write_b64 v34, v[36:37] offset:1024
    v_cvt_pk_bf16_f32 v38, v80, v81
    v_cvt_pk_bf16_f32 v39, v82, v83
    ds_write_b64 v34, v[38:39] offset:1536
    v_cvt_pk_bf16_f32 v40, v92, v93
    v_cvt_pk_bf16_f32 v41, v94, v95
    ds_write_b64 v34, v[40:41] offset:3584
    v_cvt_pk_bf16_f32 v42, v104, v105
    v_cvt_pk_bf16_f32 v43, v106, v107
    ds_write_b64 v34, v[42:43] offset:4096
    s_mov_b32 exec_lo, 0x00ff00ff
    s_mov_b32 exec_hi, 0x00ff00ff
    v_cvt_pk_bf16_f32 v36, v72, v73
    v_cvt_pk_bf16_f32 v37, v74, v75
    ds_write_b64 v35, v[36:37] offset:0
    v_cvt_pk_bf16_f32 v38, v84, v85
    v_cvt_pk_bf16_f32 v39, v86, v87
    ds_write_b64 v35, v[38:39] offset:256
    v_cvt_pk_bf16_f32 v40, v96, v97
    v_cvt_pk_bf16_f32 v41, v98, v99
    ds_write_b64 v35, v[40:41] offset:2560
    v_cvt_pk_bf16_f32 v42, v108, v109
    v_cvt_pk_bf16_f32 v43, v110, v111
    ds_write_b64 v35, v[42:43] offset:2816
    s_mov_b64 exec, -1
    s_mov_b64 exec, 1
    ds_add_u32 v2, v3 offset:4
    s_mov_b64 exec, -1
    buffer_load_dwordx4 v[140:143], v55, s[36:39], 0 offen
    buffer_load_dwordx4 v[172:175], v55, s[36:39], 0 offen offset:256
    buffer_load_dwordx4 v[144:147], v56, s[36:39], 0 offen
    buffer_load_dwordx4 v[176:179], v56, s[36:39], 0 offen offset:256
    buffer_load_dwordx4 v[148:151], v57, s[36:39], 0 offen
    buffer_load_dwordx4 v[180:183], v57, s[36:39], 0 offen offset:256
    buffer_load_dwordx4 v[152:155], v58, s[36:39], 0 offen
    buffer_load_dwordx4 v[184:187], v58, s[36:39], 0 offen offset:256
    buffer_load_dwordx4 v[156:159], v59, s[36:39], 0 offen
    buffer_load_dwordx4 v[188:191], v59, s[36:39], 0 offen offset:256
    buffer_load_dwordx4 v[192:195], v60, s[36:39], 0 offen
    buffer_load_dwordx4 v[196:199], v60, s[36:39], 0 offen offset:256
    buffer_load_dwordx4 v[200:203], v61, s[36:39], 0 offen
    buffer_load_dwordx4 v[204:207], v61, s[36:39], 0 offen offset:256
    v_and_b32 v38, 7, v252
    v_lshrrev_b32 v40, 1, v253
    v_and_b32 v41, 1, v253
    v_lshlrev_b32 v41, 3, v41
    s_lshl_b32 s33, s32, 7
    s_add_u32 s33, s33, 65792
    v_lshl_add_u32 v36, v252, 9, v41
    v_add_u32 v36, s33, v36
    s_lshr_b32 s33, s32, 1
    s_lshl_b32 s33, s33, 7
    s_add_u32 s33, s33, s64
    v_lshl_add_u32 v42, v252, 7, v41
    v_add_u32 v42, s33, v42
    v_xor_b32 v40, v40, v38
    v_xor_b32 v39, 0, v40
    v_lshl_add_u32 v44, v39, 4, v36
    v_lshl_add_u32 v48, v39, 4, v42
    v_xor_b32 v39, 2, v40
    v_lshl_add_u32 v45, v39, 4, v36
    v_lshl_add_u32 v49, v39, 4, v42
    v_xor_b32 v39, 4, v40
    v_lshl_add_u32 v46, v39, 4, v36
    v_lshl_add_u32 v50, v39, 4, v42
    v_xor_b32 v39, 6, v40
    v_lshl_add_u32 v47, v39, 4, v36
    v_lshl_add_u32 v51, v39, 4, v42
    v_lshlrev_b32 v36, 1, v253
    v_cmp_eq_u32 vcc, v36, v252
    v_add_u32 v37, 1, v36
    v_cmp_eq_u32 s[72:73], v37, v252
    v_lshrrev_b32 v38, 1, v253
    v_add_u32 v38, 8, v38
    v_cmp_eq_u32 s[74:75], v38, v252
    v_cndmask_b32_e64 v5, 0, -1, vcc
    v_cndmask_b32_e64 v6, 0, -1, s[72:73]
    v_cndmask_b32_e64 v7, 0, -1, s[74:75]
    s_mul_i32 s33, s32, 10
    v_add_u32 v40, s33, v36
    v_and_b32 v41, 7, v40
    v_xor_b32 v41, v41, v252
    v_lshlrev_b32 v41, 4, v41
    v_lshl_add_u32 v41, v40, 9, v41
    v_add_u32 v8, 65792, v41
    v_add_u32 v40, s33, v37
    v_and_b32 v41, 7, v40
    v_xor_b32 v41, v41, v252
    v_lshlrev_b32 v41, 4, v41
    v_lshl_add_u32 v41, v40, 9, v41
    v_add_u32 v9, 65792, v41
    v_add_u32 v40, s33, v38
    v_and_b32 v41, 7, v40
    v_xor_b32 v41, v41, v252
    v_lshlrev_b32 v41, 4, v41
    v_lshl_add_u32 v41, v40, 9, v41
    v_add_u32 v10, 65792, v41
    s_mul_i32 s33, s32, 10
    v_add_u32 v36, s33, v252
    v_and_b32 v37, 15, v36
    v_lshrrev_b32 v38, 4, v36
    v_lshlrev_b32 v38, 10, v38
    v_lshl_add_u32 v38, v37, 4, v38
    v_lshl_add_u32 v39, v253, 8, v38
    v_lshl_add_u32 v38, v253, 7, v38
    v_cmp_gt_u32 vcc, 32, v36
    s_nop 1
    v_cndmask_b32_e64 v11, v38, v39, vcc
    v_add_u32 v11, 86272, v11
L_sw_3:
    ds_read_b32 v36, v2 offset:4
    s_waitcnt lgkmcnt(0)
    v_readfirstlane_b32 s33, v36
    s_cmp_ge_u32 s33, 4
    s_cbranch_scc1 L_sd_4
    s_add_u32 s93, s93, 1
    s_cmp_lt_u32 s93, 2097152
    s_cbranch_scc1 L_sw_3
    s_endpgm
L_sd_4:
    s_waitcnt vmcnt(26)
    ds_read_b128 v[208:211], v26 offset:0
    ds_read_b128 v[212:215], v27 offset:0
    ds_read_b128 v[216:219], v26 offset:2048
    ds_read_b128 v[220:223], v27 offset:2048
    ds_read_b128 v[240:243], v24 offset:0
    ds_read_b128 v[244:247], v24 offset:1024
    ds_read_b128 v[248:251], v25 offset:0
    ds_read_b128 v[112:115], v24 offset:2560
    ds_read_b128 v[116:119], v24 offset:3584
    ds_read_b128 v[120:123], v25 offset:2560
    s_waitcnt vmcnt(22)
    ds_read_b128 v[224:227], v26 offset:4096
    ds_read_b128 v[228:231], v27 offset:4096
    ds_read_b128 v[232:235], v26 offset:6144
    ds_read_b128 v[236:239], v27 offset:6144
    s_waitcnt lgkmcnt(7)
    s_mov_b32 s60, 256
    s_add_u32 m0, s64, 0
    s_nop 0
    buffer_load_dwordx4 v12, s[52:55], s60 offen offset:0  lds
    buffer_load_dwordx4 v13, s[52:55], s60 offen offset:1024  lds
    buffer_load_dwordx4 v14, s[52:55], s60 offen offset:2048  lds
    buffer_load_dwordx4 v15, s[52:55], s60 offen offset:3072  lds
    v_mfma_f32_16x16x32_bf16 v[64:67], v[208:211], v[240:243], 0
    v_mfma_f32_16x16x32_bf16 v[68:71], v[208:211], v[244:247], 0
    v_mfma_f32_16x16x32_bf16 v[72:75], v[208:211], v[248:251], 0
    v_mfma_f32_16x16x32_bf16 v[76:79], v[216:219], v[240:243], 0
    v_mfma_f32_16x16x32_bf16 v[80:83], v[216:219], v[244:247], 0
    v_mfma_f32_16x16x32_bf16 v[84:87], v[216:219], v[248:251], 0
    s_waitcnt lgkmcnt(4)
    v_mfma_f32_16x16x32_bf16 v[64:67], v[212:215], v[112:115], v[64:67]
    v_mfma_f32_16x16x32_bf16 v[68:71], v[212:215], v[116:119], v[68:71]
    v_mfma_f32_16x16x32_bf16 v[72:75], v[212:215], v[120:123], v[72:75]
    v_mfma_f32_16x16x32_bf16 v[76:79], v[220:223], v[112:115], v[76:79]
    v_mfma_f32_16x16x32_bf16 v[80:83], v[220:223], v[116:119], v[80:83]
    v_mfma_f32_16x16x32_bf16 v[84:87], v[220:223], v[120:123], v[84:87]
    s_waitcnt vmcnt(22)
    ds_read_b128 v[208:211], v26 offset:8192
    ds_read_b128 v[212:215], v27 offset:8192
    ds_read_b128 v[216:219], v26 offset:10240
    ds_read_b128 v[220:223], v27 offset:10240
    s_waitcnt lgkmcnt(4)
    s_mov_b32 s61, 16640
    s_add_u32 m0, s64, 4096
    s_nop 0
    buffer_load_dwordx4 v12, s[52:55], s61 offen offset:0  lds
    buffer_load_dwordx4 v13, s[52:55], s61 offen offset:1024  lds
    buffer_load_dwordx4 v14, s[52:55], s61 offen offset:2048  lds
    buffer_load_dwordx4 v15, s[52:55], s61 offen offset:3072  lds
    v_mfma_f32_16x16x32_bf16 v[88:91], v[224:227], v[240:243], 0
    v_mfma_f32_16x16x32_bf16 v[92:95], v[224:227], v[244:247], 0
    v_mfma_f32_16x16x32_bf16 v[96:99], v[224:227], v[248:251], 0
    v_mfma_f32_16x16x32_bf16 v[100:103], v[232:235], v[240:243], 0
    v_mfma_f32_16x16x32_bf16 v[104:107], v[232:235], v[244:247], 0
    v_mfma_f32_16x16x32_bf16 v[108:111], v[232:235], v[248:251], 0
    ds_read_b128 v[240:243], v24 offset:5120
    ds_read_b128 v[244:247], v24 offset:6144
    ds_read_b128 v[248:251], v25 offset:5120
    v_mfma_f32_16x16x32_bf16 v[88:91], v[228:231], v[112:115], v[88:91]
    v_mfma_f32_16x16x32_bf16 v[92:95], v[228:231], v[116:119], v[92:95]
    v_mfma_f32_16x16x32_bf16 v[96:99], v[228:231], v[120:123], v[96:99]
    v_mfma_f32_16x16x32_bf16 v[100:103], v[236:239], v[112:115], v[100:103]
    v_mfma_f32_16x16x32_bf16 v[104:107], v[236:239], v[116:119], v[104:107]
    v_mfma_f32_16x16x32_bf16 v[108:111], v[236:239], v[120:123], v[108:111]
    ds_read_b128 v[112:115], v24 offset:7680
    ds_read_b128 v[116:119], v24 offset:8704
    ds_read_b128 v[120:123], v25 offset:7680
    s_waitcnt vmcnt(22)
    ds_read_b128 v[224:227], v26 offset:12288
    ds_read_b128 v[228:231], v27 offset:12288
    ds_read_b128 v[232:235], v26 offset:14336
    ds_read_b128 v[236:239], v27 offset:14336
    s_waitcnt lgkmcnt(7)
    s_mov_b32 s62, 384
    s_add_u32 m0, s64, 8192
    s_nop 0
    buffer_load_dwordx4 v12, s[52:55], s62 offen offset:0  lds
    buffer_load_dwordx4 v13, s[52:55], s62 offen offset:1024  lds
    buffer_load_dwordx4 v14, s[52:55], s62 offen offset:2048  lds
    buffer_load_dwordx4 v15, s[52:55], s62 offen offset:3072  lds
    v_mfma_f32_16x16x32_bf16 v[64:67], v[208:211], v[240:243], v[64:67]
    v_mfma_f32_16x16x32_bf16 v[68:71], v[208:211], v[244:247], v[68:71]
    v_mfma_f32_16x16x32_bf16 v[72:75], v[208:211], v[248:251], v[72:75]
    v_mfma_f32_16x16x32_bf16 v[76:79], v[216:219], v[240:243], v[76:79]
    v_mfma_f32_16x16x32_bf16 v[80:83], v[216:219], v[244:247], v[80:83]
    v_mfma_f32_16x16x32_bf16 v[84:87], v[216:219], v[248:251], v[84:87]
    s_waitcnt lgkmcnt(4)
    v_mfma_f32_16x16x32_bf16 v[64:67], v[212:215], v[112:115], v[64:67]
    v_mfma_f32_16x16x32_bf16 v[68:71], v[212:215], v[116:119], v[68:71]
    v_mfma_f32_16x16x32_bf16 v[72:75], v[212:215], v[120:123], v[72:75]
    v_mfma_f32_16x16x32_bf16 v[76:79], v[220:223], v[112:115], v[76:79]
    v_mfma_f32_16x16x32_bf16 v[80:83], v[220:223], v[116:119], v[80:83]
    v_mfma_f32_16x16x32_bf16 v[84:87], v[220:223], v[120:123], v[84:87]
    s_waitcnt vmcnt(8)
    ds_read_b128 v[208:211], v26 offset:0
    ds_read_b128 v[212:215], v27 offset:0
    ds_read_b128 v[216:219], v26 offset:2048
    ds_read_b128 v[220:223], v27 offset:2048
    s_waitcnt lgkmcnt(4)
    s_mov_b32 s63, 16768
    s_add_u32 m0, s64, 12288
    s_nop 0
    buffer_load_dwordx4 v12, s[52:55], s63 offen offset:0  lds
    buffer_load_dwordx4 v13, s[52:55], s63 offen offset:1024  lds
    buffer_load_dwordx4 v14, s[52:55], s63 offen offset:2048  lds
    buffer_load_dwordx4 v15, s[52:55], s63 offen offset:3072  lds
    v_mfma_f32_16x16x32_bf16 v[88:91], v[224:227], v[240:243], v[88:91]
    v_mfma_f32_16x16x32_bf16 v[92:95], v[224:227], v[244:247], v[92:95]
    v_mfma_f32_16x16x32_bf16 v[96:99], v[224:227], v[248:251], v[96:99]
    v_mfma_f32_16x16x32_bf16 v[100:103], v[232:235], v[240:243], v[100:103]
    v_mfma_f32_16x16x32_bf16 v[104:107], v[232:235], v[244:247], v[104:107]
    v_mfma_f32_16x16x32_bf16 v[108:111], v[232:235], v[248:251], v[108:111]
    ds_read_b128 v[240:243], v24 offset:10240
    ds_read_b128 v[244:247], v24 offset:11264
    ds_read_b128 v[248:251], v25 offset:10240
    v_mfma_f32_16x16x32_bf16 v[88:91], v[228:231], v[112:115], v[88:91]
    v_mfma_f32_16x16x32_bf16 v[92:95], v[228:231], v[116:119], v[92:95]
    v_mfma_f32_16x16x32_bf16 v[96:99], v[228:231], v[120:123], v[96:99]
    v_mfma_f32_16x16x32_bf16 v[100:103], v[236:239], v[112:115], v[100:103]
    v_mfma_f32_16x16x32_bf16 v[104:107], v[236:239], v[116:119], v[104:107]
    v_mfma_f32_16x16x32_bf16 v[108:111], v[236:239], v[120:123], v[108:111]
    ds_read_b128 v[112:115], v24 offset:12800
    ds_read_b128 v[116:119], v24 offset:13824
    ds_read_b128 v[120:123], v25 offset:12800
    s_waitcnt vmcnt(8)
    ds_read_b128 v[224:227], v26 offset:4096
    ds_read_b128 v[228:231], v27 offset:4096
    ds_read_b128 v[232:235], v26 offset:6144
    ds_read_b128 v[236:239], v27 offset:6144
    s_waitcnt lgkmcnt(7)
    s_mov_b32 s52, s22
    s_mov_b32 s53, s23
    s_mov_b32 s60, 0
    s_add_u32 m0, s64, 0
    s_nop 0
    buffer_load_dwordx4 v16, s[52:55], s60 offen offset:0  lds
    buffer_load_dwordx4 v17, s[52:55], s60 offen offset:1024  lds
    buffer_load_dwordx4 v18, s[52:55], s60 offen offset:2048  lds
    buffer_load_dwordx4 v19, s[52:55], s60 offen offset:3072  lds
    v_mfma_f32_16x16x32_bf16 v[64:67], v[208:211], v[240:243], v[64:67]
    v_mfma_f32_16x16x32_bf16 v[68:71], v[208:211], v[244:247], v[68:71]
    v_mfma_f32_16x16x32_bf16 v[72:75], v[208:211], v[248:251], v[72:75]
    v_mfma_f32_16x16x32_bf16 v[76:79], v[216:219], v[240:243], v[76:79]
    v_mfma_f32_16x16x32_bf16 v[80:83], v[216:219], v[244:247], v[80:83]
    v_mfma_f32_16x16x32_bf16 v[84:87], v[216:219], v[248:251], v[84:87]
    s_waitcnt lgkmcnt(4)
    v_mfma_f32_16x16x32_bf16 v[64:67], v[212:215], v[112:115], v[64:67]
    v_mfma_f32_16x16x32_bf16 v[68:71], v[212:215], v[116:119], v[68:71]
    v_mfma_f32_16x16x32_bf16 v[72:75], v[212:215], v[120:123], v[72:75]
    v_mfma_f32_16x16x32_bf16 v[76:79], v[220:223], v[112:115], v[76:79]
    v_mfma_f32_16x16x32_bf16 v[80:83], v[220:223], v[116:119], v[80:83]
    v_mfma_f32_16x16x32_bf16 v[84:87], v[220:223], v[120:123], v[84:87]
    s_waitcnt vmcnt(8)
    ds_read_b128 v[208:211], v26 offset:8192
    ds_read_b128 v[212:215], v27 offset:8192
    ds_read_b128 v[216:219], v26 offset:10240
    ds_read_b128 v[220:223], v27 offset:10240
    s_waitcnt lgkmcnt(4)
    s_mov_b32 s61, 4096
    s_add_u32 m0, s64, 4096
    s_nop 0
    buffer_load_dwordx4 v16, s[52:55], s61 offen offset:0  lds
    buffer_load_dwordx4 v17, s[52:55], s61 offen offset:1024  lds
    buffer_load_dwordx4 v18, s[52:55], s61 offen offset:2048  lds
    buffer_load_dwordx4 v19, s[52:55], s61 offen offset:3072  lds
    v_mfma_f32_16x16x32_bf16 v[88:91], v[224:227], v[240:243], v[88:91]
    v_mfma_f32_16x16x32_bf16 v[92:95], v[224:227], v[244:247], v[92:95]
    v_mfma_f32_16x16x32_bf16 v[96:99], v[224:227], v[248:251], v[96:99]
    v_mfma_f32_16x16x32_bf16 v[100:103], v[232:235], v[240:243], v[100:103]
    v_mfma_f32_16x16x32_bf16 v[104:107], v[232:235], v[244:247], v[104:107]
    v_mfma_f32_16x16x32_bf16 v[108:111], v[232:235], v[248:251], v[108:111]
    ds_read_b128 v[240:243], v24 offset:15360
    ds_read_b128 v[244:247], v24 offset:16384
    ds_read_b128 v[248:251], v25 offset:15360
    v_mfma_f32_16x16x32_bf16 v[88:91], v[228:231], v[112:115], v[88:91]
    v_mfma_f32_16x16x32_bf16 v[92:95], v[228:231], v[116:119], v[92:95]
    v_mfma_f32_16x16x32_bf16 v[96:99], v[228:231], v[120:123], v[96:99]
    v_mfma_f32_16x16x32_bf16 v[100:103], v[236:239], v[112:115], v[100:103]
    v_mfma_f32_16x16x32_bf16 v[104:107], v[236:239], v[116:119], v[104:107]
    v_mfma_f32_16x16x32_bf16 v[108:111], v[236:239], v[120:123], v[108:111]
    ds_read_b128 v[112:115], v24 offset:17920
    ds_read_b128 v[116:119], v24 offset:18944
    ds_read_b128 v[120:123], v25 offset:17920
    s_waitcnt vmcnt(8)
    ds_read_b128 v[224:227], v26 offset:12288
    ds_read_b128 v[228:231], v27 offset:12288
    ds_read_b128 v[232:235], v26 offset:14336
    ds_read_b128 v[236:239], v27 offset:14336
    s_waitcnt lgkmcnt(7)
    s_mov_b32 s62, 8192
    s_add_u32 m0, s64, 8192
    s_nop 0
    buffer_load_dwordx4 v16, s[52:55], s62 offen offset:0  lds
    buffer_load_dwordx4 v17, s[52:55], s62 offen offset:1024  lds
    buffer_load_dwordx4 v18, s[52:55], s62 offen offset:2048  lds
    buffer_load_dwordx4 v19, s[52:55], s62 offen offset:3072  lds
    v_mfma_f32_16x16x32_bf16 v[64:67], v[208:211], v[240:243], v[64:67]
    v_mfma_f32_16x16x32_bf16 v[68:71], v[208:211], v[244:247], v[68:71]
    v_mfma_f32_16x16x32_bf16 v[72:75], v[208:211], v[248:251], v[72:75]
    v_mfma_f32_16x16x32_bf16 v[76:79], v[216:219], v[240:243], v[76:79]
    v_mfma_f32_16x16x32_bf16 v[80:83], v[216:219], v[244:247], v[80:83]
    v_mfma_f32_16x16x32_bf16 v[84:87], v[216:219], v[248:251], v[84:87]
    s_waitcnt lgkmcnt(4)
    v_mfma_f32_16x16x32_bf16 v[64:67], v[212:215], v[112:115], v[64:67]
    v_mfma_f32_16x16x32_bf16 v[68:71], v[212:215], v[116:119], v[68:71]
    v_mfma_f32_16x16x32_bf16 v[72:75], v[212:215], v[120:123], v[72:75]
    v_mfma_f32_16x16x32_bf16 v[76:79], v[220:223], v[112:115], v[76:79]
    v_mfma_f32_16x16x32_bf16 v[80:83], v[220:223], v[116:119], v[80:83]
    v_mfma_f32_16x16x32_bf16 v[84:87], v[220:223], v[120:123], v[84:87]
    s_waitcnt lgkmcnt(0)
    s_mov_b32 s63, 12288
    s_add_u32 m0, s64, 12288
    s_nop 0
    buffer_load_dwordx4 v16, s[52:55], s63 offen offset:0  lds
    buffer_load_dwordx4 v17, s[52:55], s63 offen offset:1024  lds
    buffer_load_dwordx4 v18, s[52:55], s63 offen offset:2048  lds
    buffer_load_dwordx4 v19, s[52:55], s63 offen offset:3072  lds
    v_mfma_f32_16x16x32_bf16 v[88:91], v[224:227], v[240:243], v[88:91]
    v_mfma_f32_16x16x32_bf16 v[92:95], v[224:227], v[244:247], v[92:95]
    v_mfma_f32_16x16x32_bf16 v[96:99], v[224:227], v[248:251], v[96:99]
    v_mfma_f32_16x16x32_bf16 v[100:103], v[232:235], v[240:243], v[100:103]
    v_mfma_f32_16x16x32_bf16 v[104:107], v[232:235], v[244:247], v[104:107]
    v_mfma_f32_16x16x32_bf16 v[108:111], v[232:235], v[248:251], v[108:111]
    v_mfma_f32_16x16x32_bf16 v[88:91], v[228:231], v[112:115], v[88:91]
    v_mfma_f32_16x16x32_bf16 v[92:95], v[228:231], v[116:119], v[92:95]
    v_mfma_f32_16x16x32_bf16 v[96:99], v[228:231], v[120:123], v[96:99]
    v_mfma_f32_16x16x32_bf16 v[100:103], v[236:239], v[112:115], v[100:103]
    v_mfma_f32_16x16x32_bf16 v[104:107], v[236:239], v[116:119], v[104:107]
    v_mfma_f32_16x16x32_bf16 v[108:111], v[236:239], v[120:123], v[108:111]
    v_mov_b32 v12, v16
    v_mov_b32 v13, v17
    v_mov_b32 v14, v18
    v_mov_b32 v15, v19
    v_cvt_pk_bf16_f32 v36, v64, v65
    v_cvt_pk_bf16_f32 v37, v66, v67
    ds_write_b64 v44, v[36:37] offset:0
    v_cvt_pk_bf16_f32 v38, v76, v77
    v_cvt_pk_bf16_f32 v39, v78, v79
    ds_write_b64 v45, v[38:39] offset:0
    v_cvt_pk_bf16_f32 v40, v88, v89
    v_cvt_pk_bf16_f32 v41, v90, v91
    ds_write_b64 v46, v[40:41] offset:0
    v_cvt_pk_bf16_f32 v42, v100, v101
    v_cvt_pk_bf16_f32 v43, v102, v103
    ds_write_b64 v47, v[42:43] offset:0
    v_cvt_pk_bf16_f32 v36, v68, v69
    v_cvt_pk_bf16_f32 v37, v70, v71
    ds_write_b64 v44, v[36:37] offset:8192
    v_cvt_pk_bf16_f32 v38, v80, v81
    v_cvt_pk_bf16_f32 v39, v82, v83
    ds_write_b64 v45, v[38:39] offset:8192
    v_cvt_pk_bf16_f32 v40, v92, v93
    v_cvt_pk_bf16_f32 v41, v94, v95
    ds_write_b64 v46, v[40:41] offset:8192
    v_cvt_pk_bf16_f32 v42, v104, v105
    v_cvt_pk_bf16_f32 v43, v106, v107
    ds_write_b64 v47, v[42:43] offset:8192
    s_mov_b32 exec_lo, 0x00ff00ff
    s_mov_b32 exec_hi, 0x00ff00ff
    v_cvt_pk_bf16_f32 v36, v72, v73
    v_cvt_pk_bf16_f32 v37, v74, v75
    ds_write_b64 v44, v[36:37] offset:16384
    v_cvt_pk_bf16_f32 v38, v84, v85
    v_cvt_pk_bf16_f32 v39, v86, v87
    ds_write_b64 v45, v[38:39] offset:16384
    v_cvt_pk_bf16_f32 v40, v96, v97
    v_cvt_pk_bf16_f32 v41, v98, v99
    ds_write_b64 v46, v[40:41] offset:16384
    v_cvt_pk_bf16_f32 v42, v108, v109
    v_cvt_pk_bf16_f32 v43, v110, v111
    ds_write_b64 v47, v[42:43] offset:16384
    s_mov_b64 exec, -1
    s_mov_b64 exec, 1
    ds_add_u32 v2, v3 offset:8
    s_mov_b64 exec, -1
    v_mov_b32 v41, 0
    v_mov_b32 v43, 0
    v_mov_b32 v37, 0
    v_mov_b32 v39, 0
    v_mov_b32 v33, 0
    s_mov_b32 s60, 65536
    s_mov_b32 s61, 69632
    s_mov_b32 s62, 73728
    s_mov_b32 s63, 77824
    s_mov_b32 s65, 0
L_sw_5:
    ds_read_b32 v62, v2 offset:8
    s_waitcnt lgkmcnt(0)
    v_readfirstlane_b32 s33, v62
    s_cmp_ge_u32 s33, 4
    s_cbranch_scc1 L_sd_6
    s_add_u32 s93, s93, 1
    s_cmp_lt_u32 s93, 2097152
    s_cbranch_scc1 L_sw_5
    s_endpgm
L_sd_6:
    ds_read_b128 v[208:211], v8 offset:0
    ds_read_b128 v[212:215], v8 offset:256
    ds_read_b128 v[216:219], v9 offset:0
    ds_read_b128 v[220:223], v9 offset:256
    ds_read_b128 v[224:227], v10 offset:0
    ds_read_b128 v[228:231], v10 offset:256
    s_waitcnt lgkmcnt(4)
    v_dot2_f32_bf16 v52, v128, v208, 0
    v_dot2_f32_bf16 v53, v132, v208, 0
    v_dot2_f32_bf16 v54, v136, v208, 0
    v_dot2_f32_bf16 v55, v140, v208, 0
    v_dot2c_f32_bf16 v52, v129, v209
    v_dot2c_f32_bf16 v53, v133, v209
    v_dot2c_f32_bf16 v54, v137, v209
    v_dot2c_f32_bf16 v55, v141, v209
    v_dot2c_f32_bf16 v52, v130, v210
    v_dot2c_f32_bf16 v53, v134, v210
    v_dot2c_f32_bf16 v54, v138, v210
    v_dot2c_f32_bf16 v55, v142, v210
    v_dot2c_f32_bf16 v52, v131, v211
    v_dot2c_f32_bf16 v53, v135, v211
    v_dot2c_f32_bf16 v54, v139, v211
    v_dot2c_f32_bf16 v55, v143, v211
    v_dot2c_f32_bf16 v52, v160, v212
    v_dot2c_f32_bf16 v53, v164, v212
    v_dot2c_f32_bf16 v54, v168, v212
    v_dot2c_f32_bf16 v55, v172, v212
    v_dot2c_f32_bf16 v52, v161, v213
    v_dot2c_f32_bf16 v53, v165, v213
    v_dot2c_f32_bf16 v54, v169, v213
    v_dot2c_f32_bf16 v55, v173, v213
    v_dot2c_f32_bf16 v52, v162, v214
    v_dot2c_f32_bf16 v53, v166, v214
    v_dot2c_f32_bf16 v54, v170, v214
    v_dot2c_f32_bf16 v55, v174, v214
    v_dot2c_f32_bf16 v52, v163, v215
    v_dot2c_f32_bf16 v53, v167, v215
    v_dot2c_f32_bf16 v54, v171, v215
    v_dot2c_f32_bf16 v55, v175, v215
    s_waitcnt lgkmcnt(2)
    v_dot2_f32_bf16 v56, v144, v216, 0
    v_dot2_f32_bf16 v57, v148, v216, 0
    v_dot2_f32_bf16 v58, v152, v216, 0
    v_dot2_f32_bf16 v59, v156, v216, 0
    v_dot2c_f32_bf16 v56, v145, v217
    v_dot2c_f32_bf16 v57, v149, v217
    v_dot2c_f32_bf16 v58, v153, v217
    v_dot2c_f32_bf16 v59, v157, v217
    v_dot2c_f32_bf16 v56, v146, v218
    v_dot2c_f32_bf16 v57, v150, v218
    v_dot2c_f32_bf16 v58, v154, v218
    v_dot2c_f32_bf16 v59, v158, v218
    v_dot2c_f32_bf16 v56, v147, v219
    v_dot2c_f32_bf16 v57, v151, v219
    v_dot2c_f32_bf16 v58, v155, v219
    v_dot2c_f32_bf16 v59, v159, v219
    v_dot2c_f32_bf16 v56, v176, v220
    v_dot2c_f32_bf16 v57, v180, v220
    v_dot2c_f32_bf16 v58, v184, v220
    v_dot2c_f32_bf16 v59, v188, v220
    v_dot2c_f32_bf16 v56, v177, v221
    v_dot2c_f32_bf16 v57, v181, v221
    v_dot2c_f32_bf16 v58, v185, v221
    v_dot2c_f32_bf16 v59, v189, v221
    v_dot2c_f32_bf16 v56, v178, v222
    v_dot2c_f32_bf16 v57, v182, v222
    v_dot2c_f32_bf16 v58, v186, v222
    v_dot2c_f32_bf16 v59, v190, v222
    v_dot2c_f32_bf16 v56, v179, v223
    v_dot2c_f32_bf16 v57, v183, v223
    v_dot2c_f32_bf16 v58, v187, v223
    v_dot2c_f32_bf16 v59, v191, v223
    s_waitcnt lgkmcnt(0)
    v_dot2_f32_bf16 v60, v192, v224, 0
    v_dot2_f32_bf16 v61, v200, v224, 0
    s_nop 1
    v_dot2c_f32_bf16 v60, v193, v225
    v_dot2c_f32_bf16 v61, v201, v225
    v_dot2c_f32_bf16 v60, v194, v226
    v_dot2c_f32_bf16 v61, v202, v226
    v_dot2c_f32_bf16 v60, v195, v227
    v_dot2c_f32_bf16 v61, v203, v227
    v_dot2c_f32_bf16 v60, v196, v228
    v_dot2c_f32_bf16 v61, v204, v228
    v_dot2c_f32_bf16 v60, v197, v229
    v_dot2c_f32_bf16 v61, v205, v229
    v_dot2c_f32_bf16 v60, v198, v230
    v_dot2c_f32_bf16 v61, v206, v230
    v_dot2c_f32_bf16 v60, v199, v231
    v_dot2c_f32_bf16 v61, v207, v231
    s_mov_b64 exec, 1
    ds_add_u32 v2, v3 offset:64
    s_mov_b64 exec, -1
    v_add_f32_dpp v52, v52, v52 row_ror:8 row_mask:0xf bank_mask:0xf
    v_add_f32_dpp v53, v53, v53 row_ror:8 row_mask:0xf bank_mask:0xf
    v_add_f32_dpp v54, v54, v54 row_ror:8 row_mask:0xf bank_mask:0xf
    v_add_f32_dpp v55, v55, v55 row_ror:8 row_mask:0xf bank_mask:0xf
    v_add_f32_dpp v56, v56, v56 row_ror:8 row_mask:0xf bank_mask:0xf
    v_add_f32_dpp v57, v57, v57 row_ror:8 row_mask:0xf bank_mask:0xf
    v_add_f32_dpp v58, v58, v58 row_ror:8 row_mask:0xf bank_mask:0xf
    v_add_f32_dpp v59, v59, v59 row_ror:8 row_mask:0xf bank_mask:0xf
    v_add_f32_dpp v60, v60, v60 row_ror:8 row_mask:0xf bank_mask:0xf
    v_add_f32_dpp v61, v61, v61 row_ror:8 row_mask:0xf bank_mask:0xf
    v_add_f32_dpp v52, v52, v52 row_ror:4 row_mask:0xf bank_mask:0xf
    v_add_f32_dpp v53, v53, v53 row_ror:4 row_mask:0xf bank_mask:0xf
    v_add_f32_dpp v54, v54, v54 row_ror:4 row_mask:0xf bank_mask:0xf
    v_add_f32_dpp v55, v55, v55 row_ror:4 row_mask:0xf bank_mask:0xf
    v_add_f32_dpp v56, v56, v56 row_ror:4 row_mask:0xf bank_mask:0xf
    v_add_f32_dpp v57, v57, v57 row_ror:4 row_mask:0xf bank_mask:0xf
    v_add_f32_dpp v58, v58, v58 row_ror:4 row_mask:0xf bank_mask:0xf
    v_add_f32_dpp v59, v59, v59 row_ror:4 row_mask:0xf bank_mask:0xf
    v_add_f32_dpp v60, v60, v60 row_ror:4 row_mask:0xf bank_mask:0xf
    v_add_f32_dpp v61, v61, v61 row_ror:4 row_mask:0xf bank_mask:0xf
    v_add_f32_dpp v52, v52, v52 row_ror:2 row_mask:0xf bank_mask:0xf
    v_add_f32_dpp v53, v53, v53 row_ror:2 row_mask:0xf bank_mask:0xf
    v_add_f32_dpp v54, v54, v54 row_ror:2 row_mask:0xf bank_mask:0xf
    v_add_f32_dpp v55, v55, v55 row_ror:2 row_mask:0xf bank_mask:0xf
    v_add_f32_dpp v56, v56, v56 row_ror:2 row_mask:0xf bank_mask:0xf
    v_add_f32_dpp v57, v57, v57 row_ror:2 row_mask:0xf bank_mask:0xf
    v_add_f32_dpp v58, v58, v58 row_ror:2 row_mask:0xf bank_mask:0xf
    v_add_f32_dpp v59, v59, v59 row_ror:2 row_mask:0xf bank_mask:0xf
    v_add_f32_dpp v60, v60, v60 row_ror:2 row_mask:0xf bank_mask:0xf
    v_add_f32_dpp v61, v61, v61 row_ror:2 row_mask:0xf bank_mask:0xf
    v_add_f32_dpp v52, v52, v52 row_ror:1 row_mask:0xf bank_mask:0xf
    v_add_f32_dpp v53, v53, v53 row_ror:1 row_mask:0xf bank_mask:0xf
    v_add_f32_dpp v54, v54, v54 row_ror:1 row_mask:0xf bank_mask:0xf
    v_add_f32_dpp v55, v55, v55 row_ror:1 row_mask:0xf bank_mask:0xf
    v_add_f32_dpp v56, v56, v56 row_ror:1 row_mask:0xf bank_mask:0xf
    v_add_f32_dpp v57, v57, v57 row_ror:1 row_mask:0xf bank_mask:0xf
    v_add_f32_dpp v58, v58, v58 row_ror:1 row_mask:0xf bank_mask:0xf
    v_add_f32_dpp v59, v59, v59 row_ror:1 row_mask:0xf bank_mask:0xf
    v_add_f32_dpp v60, v60, v60 row_ror:1 row_mask:0xf bank_mask:0xf
    v_add_f32_dpp v61, v61, v61 row_ror:1 row_mask:0xf bank_mask:0xf
    s_mov_b32 s33, 0x3db8aa3b
    v_mul_f32 v52, s33, v52
    v_mul_f32 v53, s33, v53
    v_mul_f32 v54, s33, v54
    v_mul_f32 v55, s33, v55
    v_mul_f32 v56, s33, v56
    v_mul_f32 v57, s33, v57
    v_mul_f32 v58, s33, v58
    v_mul_f32 v59, s33, v59
    v_mul_f32 v60, s33, v60
    v_mul_f32 v61, s33, v61
    v_exp_f32 v52, v52
    v_exp_f32 v53, v53
    v_exp_f32 v54, v54
    v_exp_f32 v55, v55
    v_exp_f32 v56, v56
    v_exp_f32 v57, v57
    v_exp_f32 v58, v58
    v_exp_f32 v59, v59
    v_exp_f32 v60, v60
    v_exp_f32 v61, v61
    s_mov_b32 s33, 0x3089705f
    v_add_f32 v62, v60, v61
    v_add_f32 v28, v52, v53
    v_add_f32 v29, v54, v55
    v_mov_b32 v63, v62
    v_add_f32 v30, v56, v57
    v_add_f32 v31, v58, v59
    v_permlane16_swap_b32 v62, v63
    v_add_f32 v28, v28, v29
    v_add_f32 v30, v30, v31
    v_add_f32 v62, v62, v63
    v_add_f32 v28, s33, v28
    v_add_f32 v30, s33, v30
    v_add_f32 v62, s33, v62
    v_rcp_f32 v28, v28
    v_rcp_f32 v30, v30
    v_rcp_f32 v62, v62
    v_mul_f32 v52, v28, v52
    v_mul_f32 v53, v28, v53
    v_mul_f32 v54, v28, v54
    v_mul_f32 v55, v28, v55
    v_mul_f32 v56, v30, v56
    v_mul_f32 v57, v30, v57
    v_mul_f32 v58, v30, v58
    v_mul_f32 v59, v30, v59
    v_mul_f32 v60, v62, v60
    v_mul_f32 v61, v62, v61
    v_cvt_pk_bf16_f32 v28, v52, v53
    v_cvt_pk_bf16_f32 v29, v54, v55
    v_cvt_pk_bf16_f32 v30, v56, v57
    v_cvt_pk_bf16_f32 v31, v58, v59
    v_cvt_pk_bf16_f32 v32, v60, v61
    v_and_b32 v28, v5, v28
    v_and_b32 v29, v5, v29
    v_and_b32 v30, v6, v30
    v_and_b32 v31, v6, v31
    v_and_b32 v32, v7, v32
    v_perm_b32 v36, v200, v192, s68
    v_perm_b32 v38, v200, v192, s69
    v_perm_b32 v40, v201, v193, s68
    v_mfma_f32_16x16x16_bf16 v[64:67], v[36:37], v[32:33], 0
    v_perm_b32 v42, v201, v193, s69
    v_mfma_f32_16x16x16_bf16 v[68:71], v[38:39], v[32:33], 0
    v_perm_b32 v36, v202, v194, s68
    v_mfma_f32_16x16x16_bf16 v[72:75], v[40:41], v[32:33], 0
    v_perm_b32 v38, v202, v194, s69
    v_mfma_f32_16x16x16_bf16 v[76:79], v[42:43], v[32:33], 0
    v_perm_b32 v40, v203, v195, s68
    v_mfma_f32_16x16x16_bf16 v[80:83], v[36:37], v[32:33], 0
    v_perm_b32 v42, v203, v195, s69
    v_mfma_f32_16x16x16_bf16 v[84:87], v[38:39], v[32:33], 0
    v_perm_b32 v36, v204, v196, s68
    v_mfma_f32_16x16x16_bf16 v[88:91], v[40:41], v[32:33], 0
    v_perm_b32 v38, v204, v196, s69
    v_mfma_f32_16x16x16_bf16 v[92:95], v[42:43], v[32:33], 0
    v_perm_b32 v40, v205, v197, s68
    v_mfma_f32_16x16x16_bf16 v[96:99], v[36:37], v[32:33], 0
    v_perm_b32 v42, v205, v197, s69
    v_mfma_f32_16x16x16_bf16 v[100:103], v[38:39], v[32:33], 0
    v_perm_b32 v36, v206, v198, s68
    v_mfma_f32_16x16x16_bf16 v[104:107], v[40:41], v[32:33], 0
    v_perm_b32 v38, v206, v198, s69
    v_mfma_f32_16x16x16_bf16 v[108:111], v[42:43], v[32:33], 0
    v_perm_b32 v40, v207, v199, s68
    v_mfma_f32_16x16x16_bf16 v[112:115], v[36:37], v[32:33], 0
    v_perm_b32 v42, v207, v199, s69
    v_mfma_f32_16x16x16_bf16 v[116:119], v[38:39], v[32:33], 0
    v_mfma_f32_16x16x16_bf16 v[120:123], v[40:41], v[32:33], 0
    v_mfma_f32_16x16x16_bf16 v[124:127], v[42:43], v[32:33], 0
    v_perm_b32 v36, v132, v128, s68
    v_perm_b32 v37, v140, v136, s68
    v_perm_b32 v38, v148, v144, s68
    v_perm_b32 v39, v156, v152, s68
    v_perm_b32 v40, v132, v128, s69
    v_perm_b32 v41, v140, v136, s69
    v_perm_b32 v42, v148, v144, s69
    v_perm_b32 v43, v156, v152, s69
    v_mfma_f32_16x16x32_bf16 v[64:67], v[36:39], v[28:31], v[64:67]
    v_perm_b32 v36, v133, v129, s68
    v_perm_b32 v37, v141, v137, s68
    v_perm_b32 v38, v149, v145, s68
    v_perm_b32 v39, v157, v153, s68
    v_mfma_f32_16x16x32_bf16 v[68:71], v[40:43], v[28:31], v[68:71]
    v_perm_b32 v40, v133, v129, s69
    v_perm_b32 v41, v141, v137, s69
    v_perm_b32 v42, v149, v145, s69
    v_perm_b32 v43, v157, v153, s69
    v_mfma_f32_16x16x32_bf16 v[72:75], v[36:39], v[28:31], v[72:75]
    v_perm_b32 v36, v134, v130, s68
    v_perm_b32 v37, v142, v138, s68
    v_perm_b32 v38, v150, v146, s68
    v_perm_b32 v39, v158, v154, s68
    v_mfma_f32_16x16x32_bf16 v[76:79], v[40:43], v[28:31], v[76:79]
    v_perm_b32 v40, v134, v130, s69
    v_perm_b32 v41, v142, v138, s69
    v_perm_b32 v42, v150, v146, s69
    v_perm_b32 v43, v158, v154, s69
    v_mfma_f32_16x16x32_bf16 v[80:83], v[36:39], v[28:31], v[80:83]
    v_perm_b32 v36, v135, v131, s68
    v_perm_b32 v37, v143, v139, s68
    v_perm_b32 v38, v151, v147, s68
    v_perm_b32 v39, v159, v155, s68
    v_mfma_f32_16x16x32_bf16 v[84:87], v[40:43], v[28:31], v[84:87]
    v_perm_b32 v40, v135, v131, s69
    v_perm_b32 v41, v143, v139, s69
    v_perm_b32 v42, v151, v147, s69
    v_perm_b32 v43, v159, v155, s69
    v_mfma_f32_16x16x32_bf16 v[88:91], v[36:39], v[28:31], v[88:91]
    s_nop 0
    v_mfma_f32_16x16x32_bf16 v[92:95], v[40:43], v[28:31], v[92:95]
    v_perm_b32 v36, v164, v160, s68
    v_perm_b32 v37, v172, v168, s68
    v_perm_b32 v38, v180, v176, s68
    v_perm_b32 v39, v188, v184, s68
    v_perm_b32 v40, v164, v160, s69
    v_perm_b32 v41, v172, v168, s69
    v_perm_b32 v42, v180, v176, s69
    v_perm_b32 v43, v188, v184, s69
    v_mfma_f32_16x16x32_bf16 v[96:99], v[36:39], v[28:31], v[96:99]
    v_perm_b32 v36, v165, v161, s68
    v_perm_b32 v37, v173, v169, s68
    v_perm_b32 v38, v181, v177, s68
    v_perm_b32 v39, v189, v185, s68
    v_mfma_f32_16x16x32_bf16 v[100:103], v[40:43], v[28:31], v[100:103]
    v_perm_b32 v40, v165, v161, s69
    v_perm_b32 v41, v173, v169, s69
    v_perm_b32 v42, v181, v177, s69
    v_perm_b32 v43, v189, v185, s69
    v_mfma_f32_16x16x32_bf16 v[104:107], v[36:39], v[28:31], v[104:107]
    v_perm_b32 v36, v166, v162, s68
    v_perm_b32 v37, v174, v170, s68
    v_perm_b32 v38, v182, v178, s68
    v_perm_b32 v39, v190, v186, s68
    v_mfma_f32_16x16x32_bf16 v[108:111], v[40:43], v[28:31], v[108:111]
    v_perm_b32 v40, v166, v162, s69
    v_perm_b32 v41, v174, v170, s69
    v_perm_b32 v42, v182, v178, s69
    v_perm_b32 v43, v190, v186, s69
    v_mfma_f32_16x16x32_bf16 v[112:115], v[36:39], v[28:31], v[112:115]
    v_perm_b32 v36, v167, v163, s68
    v_perm_b32 v37, v175, v171, s68
    v_perm_b32 v38, v183, v179, s68
    v_perm_b32 v39, v191, v187, s68
    v_mfma_f32_16x16x32_bf16 v[116:119], v[40:43], v[28:31], v[116:119]
    v_perm_b32 v40, v167, v163, s69
    v_perm_b32 v41, v175, v171, s69
    v_perm_b32 v42, v183, v179, s69
    v_perm_b32 v43, v191, v187, s69
    v_mfma_f32_16x16x32_bf16 v[120:123], v[36:39], v[28:31], v[120:123]
    s_nop 0
    v_mfma_f32_16x16x32_bf16 v[124:127], v[40:43], v[28:31], v[124:127]
    s_mov_b32 exec_lo, 0x03ff03ff
    s_mov_b32 exec_hi, 0x03ff03ff
    v_cvt_pk_bf16_f32 v36, v64, v68
    v_cvt_pk_bf16_f32 v37, v72, v76
    v_cvt_pk_bf16_f32 v38, v80, v84
    v_cvt_pk_bf16_f32 v39, v88, v92
    ds_write_b128 v11, v[36:39] offset:0
    v_cvt_pk_bf16_f32 v40, v65, v69
    v_cvt_pk_bf16_f32 v41, v73, v77
    v_cvt_pk_bf16_f32 v42, v81, v85
    v_cvt_pk_bf16_f32 v43, v89, v93
    ds_write_b128 v11, v[40:43] offset:2560
    v_cvt_pk_bf16_f32 v36, v66, v70
    v_cvt_pk_bf16_f32 v37, v74, v78
    v_cvt_pk_bf16_f32 v38, v82, v86
    v_cvt_pk_bf16_f32 v39, v90, v94
    ds_write_b128 v11, v[36:39] offset:5120
    v_cvt_pk_bf16_f32 v40, v67, v71
    v_cvt_pk_bf16_f32 v41, v75, v79
    v_cvt_pk_bf16_f32 v42, v83, v87
    v_cvt_pk_bf16_f32 v43, v91, v95
    ds_write_b128 v11, v[40:43] offset:7680
    v_cvt_pk_bf16_f32 v36, v96, v100
    v_cvt_pk_bf16_f32 v37, v104, v108
    v_cvt_pk_bf16_f32 v38, v112, v116
    v_cvt_pk_bf16_f32 v39, v120, v124
    ds_write_b128 v11, v[36:39] offset:10240
    v_cvt_pk_bf16_f32 v40, v97, v101
    v_cvt_pk_bf16_f32 v41, v105, v109
    v_cvt_pk_bf16_f32 v42, v113, v117
    v_cvt_pk_bf16_f32 v43, v121, v125
    ds_write_b128 v11, v[40:43] offset:12800
    v_cvt_pk_bf16_f32 v36, v98, v102
    v_cvt_pk_bf16_f32 v37, v106, v110
    v_cvt_pk_bf16_f32 v38, v114, v118
    v_cvt_pk_bf16_f32 v39, v122, v126
    ds_write_b128 v11, v[36:39] offset:15360
    v_cvt_pk_bf16_f32 v40, v99, v103
    v_cvt_pk_bf16_f32 v41, v107, v111
    v_cvt_pk_bf16_f32 v42, v115, v119
    v_cvt_pk_bf16_f32 v43, v123, v127
    ds_write_b128 v11, v[40:43] offset:17920
    s_mov_b64 exec, -1
    s_mov_b64 exec, 1
    ds_add_u32 v2, v3 offset:12
    s_mov_b64 exec, -1
    v_mov_b32 v128, 0
    v_mov_b32 v129, 0
    v_mov_b32 v130, 0
    v_mov_b32 v131, 0
    v_mov_b32 v132, 0
    v_mov_b32 v133, 0
    v_mov_b32 v134, 0
    v_mov_b32 v135, 0
    v_mov_b32 v136, 0
    v_mov_b32 v137, 0
    v_mov_b32 v138, 0
    v_mov_b32 v139, 0
    v_mov_b32 v140, 0
    v_mov_b32 v141, 0
    v_mov_b32 v142, 0
    v_mov_b32 v143, 0
    v_mov_b32 v144, 0
    v_mov_b32 v145, 0
    v_mov_b32 v146, 0
    v_mov_b32 v147, 0
    v_mov_b32 v148, 0
    v_mov_b32 v149, 0
    v_mov_b32 v150, 0
    v_mov_b32 v151, 0
    v_mov_b32 v152, 0
    v_mov_b32 v153, 0
    v_mov_b32 v154, 0
    v_mov_b32 v155, 0
    v_mov_b32 v156, 0
    v_mov_b32 v157, 0
    v_mov_b32 v158, 0
    v_mov_b32 v159, 0
    v_mov_b32 v160, 0
    v_mov_b32 v161, 0
    v_mov_b32 v162, 0
    v_mov_b32 v163, 0
    v_mov_b32 v164, 0
    v_mov_b32 v165, 0
    v_mov_b32 v166, 0
    v_mov_b32 v167, 0
    v_mov_b32 v168, 0
    v_mov_b32 v169, 0
    v_mov_b32 v170, 0
    v_mov_b32 v171, 0
    v_mov_b32 v172, 0
    v_mov_b32 v173, 0
    v_mov_b32 v174, 0
    v_mov_b32 v175, 0
L_sw_7:
    ds_read_b32 v36, v2 offset:12
    s_waitcnt lgkmcnt(0)
    v_readfirstlane_b32 s33, v36
    s_cmp_ge_u32 s33, 4
    s_cbranch_scc1 L_sd_8
    s_add_u32 s93, s93, 1
    s_cmp_lt_u32 s93, 2097152
    s_cbranch_scc1 L_sw_7
    s_endpgm
L_sd_8:
L_g3:
    s_cmp_eq_u32 s65, 1
    s_waitcnt vmcnt(12)
    ds_read_b64_tr_b16 v[208:209], v20 offset:0
    ds_read_b64_tr_b16 v[210:211], v20 offset:512
    ds_read_b64_tr_b16 v[212:213], v21 offset:0
    ds_read_b64_tr_b16 v[214:215], v21 offset:512
    ds_read_b64_tr_b16 v[216:217], v22 offset:0
    ds_read_b64_tr_b16 v[218:219], v22 offset:512
    ds_read_b64_tr_b16 v[220:221], v23 offset:0
    ds_read_b64_tr_b16 v[222:223], v23 offset:512
    ds_read_b128 v[240:243], v24 offset:0
    ds_read_b128 v[244:247], v24 offset:1024
    ds_read_b128 v[248:251], v25 offset:0
    s_waitcnt vmcnt(8)
    ds_read_b64_tr_b16 v[224:225], v20 offset:4096
    ds_read_b64_tr_b16 v[226:227], v20 offset:4608
    ds_read_b64_tr_b16 v[228:229], v21 offset:4096
    ds_read_b64_tr_b16 v[230:231], v21 offset:4608
    ds_read_b64_tr_b16 v[232:233], v22 offset:4096
    ds_read_b64_tr_b16 v[234:235], v22 offset:4608
    ds_read_b64_tr_b16 v[236:237], v23 offset:4096
    ds_read_b64_tr_b16 v[238:239], v23 offset:4608
    ds_read_b128 v[112:115], v24 offset:2560
    ds_read_b128 v[116:119], v24 offset:3584
    ds_read_b128 v[120:123], v25 offset:2560
    s_waitcnt lgkmcnt(11)
    s_cbranch_scc1 L_i_9
    s_add_u32 m0, s64, 0
    s_nop 0
    buffer_load_dwordx4 v12, s[52:55], s60 offen offset:0  lds
    buffer_load_dwordx4 v13, s[52:55], s60 offen offset:1024  lds
    buffer_load_dwordx4 v14, s[52:55], s60 offen offset:2048  lds
    buffer_load_dwordx4 v15, s[52:55], s60 offen offset:3072  lds
    s_cmp_eq_u32 s65, 1
L_i_9:
    v_mfma_f32_16x16x32_bf16 v[128:131], v[208:211], v[240:243], v[128:131]
    v_mfma_f32_16x16x32_bf16 v[132:135], v[208:211], v[244:247], v[132:135]
    v_mfma_f32_16x16x32_bf16 v[136:139], v[208:211], v[248:251], v[136:139]
    v_mfma_f32_16x16x32_bf16 v[140:143], v[212:215], v[240:243], v[140:143]
    v_mfma_f32_16x16x32_bf16 v[144:147], v[212:215], v[244:247], v[144:147]
    v_mfma_f32_16x16x32_bf16 v[148:151], v[212:215], v[248:251], v[148:151]
    v_mfma_f32_16x16x32_bf16 v[152:155], v[216:219], v[240:243], v[152:155]
    v_mfma_f32_16x16x32_bf16 v[156:159], v[216:219], v[244:247], v[156:159]
    v_mfma_f32_16x16x32_bf16 v[160:163], v[216:219], v[248:251], v[160:163]
    v_mfma_f32_16x16x32_bf16 v[164:167], v[220:223], v[240:243], v[164:167]
    v_mfma_f32_16x16x32_bf16 v[168:171], v[220:223], v[244:247], v[168:171]
    v_mfma_f32_16x16x32_bf16 v[172:175], v[220:223], v[248:251], v[172:175]
    s_waitcnt vmcnt(8)
    s_cbranch_scc0 L_w_10
    s_waitcnt vmcnt(4)
L_w_10:
    ds_read_b64_tr_b16 v[208:209], v20 offset:8192
    ds_read_b64_tr_b16 v[210:211], v20 offset:8704
    ds_read_b64_tr_b16 v[212:213], v21 offset:8192
    ds_read_b64_tr_b16 v[214:215], v21 offset:8704
    ds_read_b64_tr_b16 v[216:217], v22 offset:8192
    ds_read_b64_tr_b16 v[218:219], v22 offset:8704
    ds_read_b64_tr_b16 v[220:221], v23 offset:8192
    ds_read_b64_tr_b16 v[222:223], v23 offset:8704
    ds_read_b128 v[240:243], v24 offset:5120
    ds_read_b128 v[244:247], v24 offset:6144
    ds_read_b128 v[248:251], v25 offset:5120
    s_waitcnt lgkmcnt(11)
    s_cbranch_scc1 L_i_11
    s_add_u32 m0, s64, 4096
    s_nop 0
    buffer_load_dwordx4 v12, s[52:55], s61 offen offset:0  lds
    buffer_load_dwordx4 v13, s[52:55], s61 offen offset:1024  lds
    buffer_load_dwordx4 v14, s[52:55], s61 offen offset:2048  lds
    buffer_load_dwordx4 v15, s[52:55], s61 offen offset:3072  lds
    s_cmp_eq_u32 s65, 1
L_i_11:
    v_mfma_f32_16x16x32_bf16 v[128:131], v[224:227], v[112:115], v[128:131]
    v_mfma_f32_16x16x32_bf16 v[132:135], v[224:227], v[116:119], v[132:135]
    v_mfma_f32_16x16x32_bf16 v[136:139], v[224:227], v[120:123], v[136:139]
    v_mfma_f32_16x16x32_bf16 v[140:143], v[228:231], v[112:115], v[140:143]
    v_mfma_f32_16x16x32_bf16 v[144:147], v[228:231], v[116:119], v[144:147]
    v_mfma_f32_16x16x32_bf16 v[148:151], v[228:231], v[120:123], v[148:151]
    v_mfma_f32_16x16x32_bf16 v[152:155], v[232:235], v[112:115], v[152:155]
    v_mfma_f32_16x16x32_bf16 v[156:159], v[232:235], v[116:119], v[156:159]
    v_mfma_f32_16x16x32_bf16 v[160:163], v[232:235], v[120:123], v[160:163]
    v_mfma_f32_16x16x32_bf16 v[164:167], v[236:239], v[112:115], v[164:167]
    v_mfma_f32_16x16x32_bf16 v[168:171], v[236:239], v[116:119], v[168:171]
    v_mfma_f32_16x16x32_bf16 v[172:175], v[236:239], v[120:123], v[172:175]
    s_waitcnt vmcnt(8)
    s_cbranch_scc0 L_w_12
    s_waitcnt vmcnt(0)
L_w_12:
    ds_read_b64_tr_b16 v[224:225], v20 offset:12288
    ds_read_b64_tr_b16 v[226:227], v20 offset:12800
    ds_read_b64_tr_b16 v[228:229], v21 offset:12288
    ds_read_b64_tr_b16 v[230:231], v21 offset:12800
    ds_read_b64_tr_b16 v[232:233], v22 offset:12288
    ds_read_b64_tr_b16 v[234:235], v22 offset:12800
    ds_read_b64_tr_b16 v[236:237], v23 offset:12288
    ds_read_b64_tr_b16 v[238:239], v23 offset:12800
    ds_read_b128 v[112:115], v24 offset:7680
    ds_read_b128 v[116:119], v24 offset:8704
    ds_read_b128 v[120:123], v25 offset:7680
    s_waitcnt lgkmcnt(11)
    s_cbranch_scc1 L_i_13
    s_add_u32 m0, s64, 8192
    s_nop 0
    buffer_load_dwordx4 v12, s[52:55], s62 offen offset:0  lds
    buffer_load_dwordx4 v13, s[52:55], s62 offen offset:1024  lds
    buffer_load_dwordx4 v14, s[52:55], s62 offen offset:2048  lds
    buffer_load_dwordx4 v15, s[52:55], s62 offen offset:3072  lds
    s_cmp_eq_u32 s65, 1
L_i_13:
    v_mfma_f32_16x16x32_bf16 v[128:131], v[208:211], v[240:243], v[128:131]
    v_mfma_f32_16x16x32_bf16 v[132:135], v[208:211], v[244:247], v[132:135]
    v_mfma_f32_16x16x32_bf16 v[136:139], v[208:211], v[248:251], v[136:139]
    v_mfma_f32_16x16x32_bf16 v[140:143], v[212:215], v[240:243], v[140:143]
    v_mfma_f32_16x16x32_bf16 v[144:147], v[212:215], v[244:247], v[144:147]
    v_mfma_f32_16x16x32_bf16 v[148:151], v[212:215], v[248:251], v[148:151]
    v_mfma_f32_16x16x32_bf16 v[152:155], v[216:219], v[240:243], v[152:155]
    v_mfma_f32_16x16x32_bf16 v[156:159], v[216:219], v[244:247], v[156:159]
    v_mfma_f32_16x16x32_bf16 v[160:163], v[216:219], v[248:251], v[160:163]
    v_mfma_f32_16x16x32_bf16 v[164:167], v[220:223], v[240:243], v[164:167]
    v_mfma_f32_16x16x32_bf16 v[168:171], v[220:223], v[244:247], v[168:171]
    v_mfma_f32_16x16x32_bf16 v[172:175], v[220:223], v[248:251], v[172:175]
    s_waitcnt lgkmcnt(0)
    s_cbranch_scc1 L_i_14
    s_add_u32 m0, s64, 12288
    s_nop 0
    buffer_load_dwordx4 v12, s[52:55], s63 offen offset:0  lds
    buffer_load_dwordx4 v13, s[52:55], s63 offen offset:1024  lds
    buffer_load_dwordx4 v14, s[52:55], s63 offen offset:2048  lds
    buffer_load_dwordx4 v15, s[52:55], s63 offen offset:3072  lds
    s_cmp_eq_u32 s65, 1
L_i_14:
    v_mfma_f32_16x16x32_bf16 v[128:131], v[224:227], v[112:115], v[128:131]
    v_mfma_f32_16x16x32_bf16 v[132:135], v[224:227], v[116:119], v[132:135]
    v_mfma_f32_16x16x32_bf16 v[136:139], v[224:227], v[120:123], v[136:139]
    v_mfma_f32_16x16x32_bf16 v[140:143], v[228:231], v[112:115], v[140:143]
    v_mfma_f32_16x16x32_bf16 v[144:147], v[228:231], v[116:119], v[144:147]
    v_mfma_f32_16x16x32_bf16 v[148:151], v[228:231], v[120:123], v[148:151]
    v_mfma_f32_16x16x32_bf16 v[152:155], v[232:235], v[112:115], v[152:155]
    v_mfma_f32_16x16x32_bf16 v[156:159], v[232:235], v[116:119], v[156:159]
    v_mfma_f32_16x16x32_bf16 v[160:163], v[232:235], v[120:123], v[160:163]
    v_mfma_f32_16x16x32_bf16 v[164:167], v[236:239], v[112:115], v[164:167]
    v_mfma_f32_16x16x32_bf16 v[168:171], v[236:239], v[116:119], v[168:171]
    v_mfma_f32_16x16x32_bf16 v[172:175], v[236:239], v[120:123], v[172:175]
    s_add_u32 s65, s65, 1
    s_cmp_eq_u32 s65, 3
    s_cbranch_scc1 L_g3_last
    s_cmp_eq_u32 s65, 2
    s_cbranch_scc1 L_g3_mid
    v_add_u32 v24, 10240, v24
    v_add_u32 v25, 10240, v25
    s_mov_b32 s52, s16
    s_mov_b32 s53, s17
    s_mov_b32 s60, 0
    s_mov_b32 s61, 4096
    s_mov_b32 s62, 8192
    s_mov_b32 s63, 12288
    s_branch L_g3
L_g3_mid:
    v_subrev_u32 v24, 30720, v24
    v_subrev_u32 v25, 30720, v25
L_sw_15:
    ds_read_b32 v36, v2 offset:76
    s_waitcnt lgkmcnt(0)
    v_readfirstlane_b32 s33, v36
    s_bcnt1_i32_b32 s33, s33
    s_cmp_ge_u32 s33, 4
    s_cbranch_scc1 L_sd_16
    s_add_u32 s93, s93, 1
    s_cmp_lt_u32 s93, 2097152
    s_cbranch_scc1 L_sw_15
    s_endpgm
L_sd_16:
    s_add_u32 m0, s64, 0
    s_nop 0
    buffer_load_dwordx4 v12, s[52:55], s60 offen offset:0  lds
    buffer_load_dwordx4 v13, s[52:55], s60 offen offset:1024  lds
    buffer_load_dwordx4 v14, s[52:55], s60 offen offset:2048  lds
    buffer_load_dwordx4 v15, s[52:55], s60 offen offset:3072  lds
    s_add_u32 m0, s64, 4096
    s_nop 0
    buffer_load_dwordx4 v12, s[52:55], s61 offen offset:0  lds
    buffer_load_dwordx4 v13, s[52:55], s61 offen offset:1024  lds
    buffer_load_dwordx4 v14, s[52:55], s61 offen offset:2048  lds
    buffer_load_dwordx4 v15, s[52:55], s61 offen offset:3072  lds
    s_add_u32 m0, s64, 8192
    s_nop 0
    buffer_load_dwordx4 v12, s[52:55], s62 offen offset:0  lds
    buffer_load_dwordx4 v13, s[52:55], s62 offen offset:1024  lds
    buffer_load_dwordx4 v14, s[52:55], s62 offen offset:2048  lds
    buffer_load_dwordx4 v15, s[52:55], s62 offen offset:3072  lds
    s_add_u32 m0, s64, 12288
    s_nop 0
    buffer_load_dwordx4 v12, s[52:55], s63 offen offset:0  lds
    buffer_load_dwordx4 v13, s[52:55], s63 offen offset:1024  lds
    buffer_load_dwordx4 v14, s[52:55], s63 offen offset:2048  lds
    buffer_load_dwordx4 v15, s[52:55], s63 offen offset:3072  lds
    s_mov_b32 s60, 65536
    s_mov_b32 s61, 69632
    s_mov_b32 s62, 73728
    s_mov_b32 s63, 77824
L_sw_17:
    ds_read_b32 v36, v2 offset:68
    s_waitcnt lgkmcnt(0)
    v_readfirstlane_b32 s33, v36
    s_cmp_ge_u32 s33, 4
    s_cbranch_scc1 L_sd_18
    s_add_u32 s93, s93, 1
    s_cmp_lt_u32 s93, 2097152
    s_cbranch_scc1 L_sw_17
    s_endpgm
L_sd_18:
    s_branch L_g3
L_g3_last:
    s_waitcnt vmcnt(12)
    ds_read_b64_tr_b16 v[64:65], v20 offset:0
    ds_read_b64_tr_b16 v[66:67], v20 offset:512
    ds_read_b64_tr_b16 v[68:69], v21 offset:0
    ds_read_b64_tr_b16 v[70:71], v21 offset:512
    ds_read_b64_tr_b16 v[72:73], v22 offset:0
    ds_read_b64_tr_b16 v[74:75], v22 offset:512
    ds_read_b64_tr_b16 v[76:77], v23 offset:0
    ds_read_b64_tr_b16 v[78:79], v23 offset:512
    s_waitcnt vmcnt(8)
    ds_read_b64_tr_b16 v[80:81], v20 offset:4096
    ds_read_b64_tr_b16 v[82:83], v20 offset:4608
    ds_read_b64_tr_b16 v[84:85], v21 offset:4096
    ds_read_b64_tr_b16 v[86:87], v21 offset:4608
    ds_read_b64_tr_b16 v[88:89], v22 offset:4096
    ds_read_b64_tr_b16 v[90:91], v22 offset:4608
    ds_read_b64_tr_b16 v[92:93], v23 offset:4096
    ds_read_b64_tr_b16 v[94:95], v23 offset:4608
    s_waitcnt vmcnt(4)
    ds_read_b64_tr_b16 v[96:97], v20 offset:8192
    ds_read_b64_tr_b16 v[98:99], v20 offset:8704
    ds_read_b64_tr_b16 v[100:101], v21 offset:8192
    ds_read_b64_tr_b16 v[102:103], v21 offset:8704
    ds_read_b64_tr_b16 v[104:105], v22 offset:8192
    ds_read_b64_tr_b16 v[106:107], v22 offset:8704
    ds_read_b64_tr_b16 v[108:109], v23 offset:8192
    ds_read_b64_tr_b16 v[110:111], v23 offset:8704
    s_waitcnt vmcnt(0)
    ds_read_b64_tr_b16 v[176:177], v20 offset:12288
    ds_read_b64_tr_b16 v[178:179], v20 offset:12800
    ds_read_b64_tr_b16 v[180:181], v21 offset:12288
    ds_read_b64_tr_b16 v[182:183], v21 offset:12800
    ds_read_b64_tr_b16 v[184:185], v22 offset:12288
    ds_read_b64_tr_b16 v[186:187], v22 offset:12800
    ds_read_b64_tr_b16 v[188:189], v23 offset:12288
    ds_read_b64_tr_b16 v[190:191], v23 offset:12800
    v_lshrrev_b32 v36, 3, v1
    v_and_b32 v37, 7, v1
    v_xor_b32 v26, v36, v37
    v_lshlrev_b32 v26, 4, v26
    v_lshl_add_u32 v26, v36, 7, v26
    s_lshr_b32 s33, s32, 1
    s_lshl_b32 s33, s33, 7
    s_add_u32 s33, s33, s64
    v_add_u32 v26, s33, v26
    v_lshlrev_b32 v27, 4, v37
    v_lshl_add_u32 v27, v36, 9, v27
    s_lshl_b32 s33, s32, 7
    v_add_u32 v27, s33, v27
    s_lshl_b32 s72, s12, 9
    s_add_u32 s73, s72, 4096
    s_add_u32 s74, s72, 8192
    s_add_u32 s75, s72, 12288
    s_add_u32 s76, s72, 16384
    s_sub_u32 s34, 40, s13
    s_lshl_b32 s34, s34, 3
    s_lshr_b64 s[78:79], -1, s34
    s_cmp_eq_u32 s13, 32
    s_cselect_b64 s[78:79], 0, s[78:79]
L_sw_19:
    ds_read_b32 v36, v2 offset:16
    s_waitcnt lgkmcnt(0)
    v_readfirstlane_b32 s33, v36
    s_cmp_ge_u32 s33, 4
    s_cbranch_scc1 L_sd_20
    s_add_u32 s93, s93, 1
    s_cmp_lt_u32 s93, 2097152
    s_cbranch_scc1 L_sw_19
    s_endpgm
L_sd_20:
    ds_read_b128 v[240:243], v24 offset:10240
    ds_read_b128 v[244:247], v24 offset:12800
    ds_read_b128 v[248:251], v24 offset:15360
    ds_read_b128 v[112:115], v24 offset:17920
    ds_read_b128 v[116:119], v24 offset:11264
    ds_read_b128 v[120:123], v24 offset:13824
    ds_read_b128 v[208:211], v24 offset:16384
    ds_read_b128 v[212:215], v24 offset:18944
    ds_read_b128 v[216:219], v25 offset:10240
    ds_read_b128 v[220:223], v25 offset:12800
    ds_read_b128 v[224:227], v25 offset:15360
    ds_read_b128 v[228:231], v25 offset:17920
    s_waitcnt lgkmcnt(11)
    v_mfma_f32_16x16x32_bf16 v[128:131], v[64:67], v[240:243], v[128:131]
    v_mfma_f32_16x16x32_bf16 v[140:143], v[68:71], v[240:243], v[140:143]
    v_mfma_f32_16x16x32_bf16 v[152:155], v[72:75], v[240:243], v[152:155]
    v_mfma_f32_16x16x32_bf16 v[164:167], v[76:79], v[240:243], v[164:167]
    s_waitcnt lgkmcnt(10)
    v_mfma_f32_16x16x32_bf16 v[128:131], v[80:83], v[244:247], v[128:131]
    v_mfma_f32_16x16x32_bf16 v[140:143], v[84:87], v[244:247], v[140:143]
    v_mfma_f32_16x16x32_bf16 v[152:155], v[88:91], v[244:247], v[152:155]
    v_mfma_f32_16x16x32_bf16 v[164:167], v[92:95], v[244:247], v[164:167]
    s_waitcnt lgkmcnt(9)
    v_mfma_f32_16x16x32_bf16 v[128:131], v[96:99], v[248:251], v[128:131]
    v_mfma_f32_16x16x32_bf16 v[140:143], v[100:103], v[248:251], v[140:143]
    v_mfma_f32_16x16x32_bf16 v[152:155], v[104:107], v[248:251], v[152:155]
    v_mfma_f32_16x16x32_bf16 v[164:167], v[108:111], v[248:251], v[164:167]
    s_waitcnt lgkmcnt(8)
    v_mfma_f32_16x16x32_bf16 v[128:131], v[176:179], v[112:115], v[128:131]
    v_mfma_f32_16x16x32_bf16 v[140:143], v[180:183], v[112:115], v[140:143]
    v_mfma_f32_16x16x32_bf16 v[152:155], v[184:187], v[112:115], v[152:155]
    v_mfma_f32_16x16x32_bf16 v[164:167], v[188:191], v[112:115], v[164:167]
    s_waitcnt lgkmcnt(7)
    v_mfma_f32_16x16x32_bf16 v[132:135], v[64:67], v[116:119], v[132:135]
    v_mfma_f32_16x16x32_bf16 v[144:147], v[68:71], v[116:119], v[144:147]
    v_mfma_f32_16x16x32_bf16 v[156:159], v[72:75], v[116:119], v[156:159]
    v_mfma_f32_16x16x32_bf16 v[168:171], v[76:79], v[116:119], v[168:171]
    v_cvt_pk_bf16_f32 v36, v128, v129
    v_cvt_pk_bf16_f32 v37, v130, v131
    s_waitcnt lgkmcnt(6)
    v_mfma_f32_16x16x32_bf16 v[132:135], v[80:83], v[120:123], v[132:135]
    ds_write_b64 v48, v[36:37] offset:0
    v_mfma_f32_16x16x32_bf16 v[144:147], v[84:87], v[120:123], v[144:147]
    v_cvt_pk_bf16_f32 v38, v140, v141
    v_cvt_pk_bf16_f32 v39, v142, v143
    v_mfma_f32_16x16x32_bf16 v[156:159], v[88:91], v[120:123], v[156:159]
    ds_write_b64 v49, v[38:39] offset:0
    v_mfma_f32_16x16x32_bf16 v[168:171], v[92:95], v[120:123], v[168:171]
    v_cvt_pk_bf16_f32 v40, v152, v153
    v_cvt_pk_bf16_f32 v41, v154, v155
    s_waitcnt lgkmcnt(7)
    v_mfma_f32_16x16x32_bf16 v[132:135], v[96:99], v[208:211], v[132:135]
    ds_write_b64 v50, v[40:41] offset:0
    v_mfma_f32_16x16x32_bf16 v[144:147], v[100:103], v[208:211], v[144:147]
    v_cvt_pk_bf16_f32 v42, v164, v165
    v_cvt_pk_bf16_f32 v43, v166, v167
    v_mfma_f32_16x16x32_bf16 v[156:159], v[104:107], v[208:211], v[156:159]
    ds_write_b64 v51, v[42:43] offset:0
    v_mfma_f32_16x16x32_bf16 v[168:171], v[108:111], v[208:211], v[168:171]
    ds_read_b128 v[232:235], v26 offset:0
    s_waitcnt lgkmcnt(9)
    v_mfma_f32_16x16x32_bf16 v[132:135], v[176:179], v[212:215], v[132:135]
    ds_read_b128 v[236:239], v26 offset:1024
    v_mfma_f32_16x16x32_bf16 v[144:147], v[180:183], v[212:215], v[144:147]
    v_mfma_f32_16x16x32_bf16 v[156:159], v[184:187], v[212:215], v[156:159]
    v_mfma_f32_16x16x32_bf16 v[168:171], v[188:191], v[212:215], v[168:171]
    s_waitcnt lgkmcnt(9)
    v_mfma_f32_16x16x32_bf16 v[136:139], v[64:67], v[216:219], v[136:139]
    v_mfma_f32_16x16x32_bf16 v[148:151], v[68:71], v[216:219], v[148:151]
    s_waitcnt lgkmcnt(1)
    buffer_store_dwordx4 v[232:235], v27, s[40:43], s72 offen sc0 sc1
    v_mfma_f32_16x16x32_bf16 v[160:163], v[72:75], v[216:219], v[160:163]
    s_waitcnt lgkmcnt(0)
    buffer_store_dwordx4 v[236:239], v27, s[40:43], s73 offen sc0 sc1
    v_mfma_f32_16x16x32_bf16 v[172:175], v[76:79], v[216:219], v[172:175]
    v_cvt_pk_bf16_f32 v36, v132, v133
    v_cvt_pk_bf16_f32 v37, v134, v135
    v_mfma_f32_16x16x32_bf16 v[136:139], v[80:83], v[220:223], v[136:139]
    ds_write_b64 v48, v[36:37] offset:2048
    v_mfma_f32_16x16x32_bf16 v[148:151], v[84:87], v[220:223], v[148:151]
    v_cvt_pk_bf16_f32 v38, v144, v145
    v_cvt_pk_bf16_f32 v39, v146, v147
    v_mfma_f32_16x16x32_bf16 v[160:163], v[88:91], v[220:223], v[160:163]
    ds_write_b64 v49, v[38:39] offset:2048
    v_mfma_f32_16x16x32_bf16 v[172:175], v[92:95], v[220:223], v[172:175]
    v_cvt_pk_bf16_f32 v40, v156, v157
    v_cvt_pk_bf16_f32 v41, v158, v159
    v_mfma_f32_16x16x32_bf16 v[136:139], v[96:99], v[224:227], v[136:139]
    ds_write_b64 v50, v[40:41] offset:2048
    v_mfma_f32_16x16x32_bf16 v[148:151], v[100:103], v[224:227], v[148:151]
    v_cvt_pk_bf16_f32 v42, v168, v169
    v_cvt_pk_bf16_f32 v43, v170, v171
    v_mfma_f32_16x16x32_bf16 v[160:163], v[104:107], v[224:227], v[160:163]
    ds_write_b64 v51, v[42:43] offset:2048
    v_mfma_f32_16x16x32_bf16 v[172:175], v[108:111], v[224:227], v[172:175]
    ds_read_b128 v[52:55], v26 offset:2048
    v_mfma_f32_16x16x32_bf16 v[136:139], v[176:179], v[228:231], v[136:139]
    ds_read_b128 v[56:59], v26 offset:3072
    v_mfma_f32_16x16x32_bf16 v[148:151], v[180:183], v[228:231], v[148:151]
    v_mfma_f32_16x16x32_bf16 v[160:163], v[184:187], v[228:231], v[160:163]
    v_mfma_f32_16x16x32_bf16 v[172:175], v[188:191], v[228:231], v[172:175]
    s_waitcnt lgkmcnt(1)
    buffer_store_dwordx4 v[52:55], v27, s[40:43], s74 offen sc0 sc1
    s_waitcnt lgkmcnt(0)
    buffer_store_dwordx4 v[56:59], v27, s[40:43], s75 offen sc0 sc1
    v_cvt_pk_bf16_f32 v36, v136, v137
    v_cvt_pk_bf16_f32 v37, v138, v139
    ds_write_b64 v48, v[36:37] offset:4096
    v_cvt_pk_bf16_f32 v38, v148, v149
    v_cvt_pk_bf16_f32 v39, v150, v151
    ds_write_b64 v49, v[38:39] offset:4096
    v_cvt_pk_bf16_f32 v40, v160, v161
    v_cvt_pk_bf16_f32 v41, v162, v163
    ds_write_b64 v50, v[40:41] offset:4096
    v_cvt_pk_bf16_f32 v42, v172, v173
    v_cvt_pk_bf16_f32 v43, v174, v175
    ds_write_b64 v51, v[42:43] offset:4096
    ds_read_b128 v[4:7], v26 offset:4096
    s_waitcnt lgkmcnt(0)
    s_mov_b64 exec, s[78:79]
    buffer_store_dwordx4 v[4:7], v27, s[40:43], s76 offen sc0 sc1
    s_mov_b64 exec, -1
    s_branch L_A_done
L_A:
    s_setprio 1
    s_mul_i32 s33, s2, 10000
    s_movk_i32 s34, 4096
    s_movk_i32 s35, 8192
    v_lshl_add_u32 v62, s32, 6, v1
    v_lshlrev_b32 v63, 3, v62
    v_cmp_gt_u32 vcc, 226, v62
    v_lshlrev_b32 v62, 4, v62
    s_mov_b64 s[96:97], vcc
    s_waitcnt lgkmcnt(0)
    s_mov_b32 s36, s4
    s_mov_b32 s37, s5
    s_mov_b32 s38, 5120000
    s_mov_b32 s39, 0x20000
    s_cmp_ge_u32 s2, 64
    s_cbranch_scc1 L_A_noedges
    s_add_u32 s48, s8, s33
    s_addc_u32 s49, s9, 0
    s_mov_b32 s50, 10000
    s_mov_b32 s51, 0x20000
    s_add_u32 s44, s6, s33
    s_addc_u32 s45, s7, 0
    s_mov_b32 s46, 10000
    s_mov_b32 s47, 0x20000
    buffer_load_dwordx4 v[128:131], v62, s[48:51], 0 offen
    buffer_load_dwordx4 v[138:141], v62, s[44:47], 0 offen
    buffer_load_dwordx4 v[132:135], v62, s[48:51], s34 offen
    buffer_load_dwordx4 v[142:145], v62, s[44:47], s34 offen
    buffer_load_dwordx2 v[136:137], v63, s[48:51], s35 offen
    buffer_load_dwordx2 v[146:147], v63, s[44:47], s35 offen
L_A_noedges:
    global_load_dword v15, v2, s[28:29] sc1
    s_cmp_ge_u32 s2, 64
    s_cbranch_scc1 L_b0a
    v_mov_b32 v64, 1032192
    v_mov_b32 v65, 1032192
    v_mov_b32 v66, 1032192
    v_mov_b32 v67, 1032192
    v_lshl_add_u32 v68, s3, 6, v1
    v_lshlrev_b32 v68, 4, v68
    v_add_u32 v68, 131072, v68
    ds_write_b128 v68, v[64:67] offset:0
    ds_write_b128 v68, v[64:67] offset:8192
    ds_write_b128 v68, v[64:67] offset:16384
    ds_write_b128 v68, v[64:67] offset:24576
L_b0a:
    s_waitcnt lgkmcnt(0)
    s_barrier
    s_mov_b32 s56, s14
    s_mov_b32 s57, s15
    s_mov_b32 s58, 20000
    s_mov_b32 s59, 0x20000
    s_add_u32 s60, s28, 65536
    s_addc_u32 s61, s29, 0
    s_mov_b32 s62, 2097152
    s_mov_b32 s63, 0x20000
    s_mov_b32 s88, 106752
    s_mov_b32 s89, 131072
    s_movk_i32 s98, 512
    s_movk_i32 s99, 0x7000
    s_movk_i32 s53, 0xc00
    s_mov_b32 s67, 0
    s_mov_b32 s71, 0
    s_mov_b32 s52, 0
    v_lshrrev_b32 v62, 4, v1
    v_and_b32 v63, 15, v1
    v_lshlrev_b32 v4, 4, v63
    s_mul_i32 s33, s32, 10
    v_add_u32 v40, s33, v63
    v_and_b32 v41, 15, v40
    v_lshrrev_b32 v42, 4, v40
    v_lshlrev_b32 v42, 10, v42
    v_lshl_add_u32 v42, v41, 4, v42
    v_lshl_add_u32 v43, v62, 8, v42
    v_lshl_add_u32 v42, v62, 7, v42
    v_cmp_gt_u32 vcc, 32, v40
    s_nop 1
    v_cndmask_b32_e64 v11, v42, v43, vcc
    v_add_u32 v11, 65792, v11
    v_add_u32 v12, s12, v40
    v_lshl_add_u32 v12, v12, 1, s88
    v_lshrrev_b32 v62, 4, v1
    s_lshl_b32 s33, s32, 8
    s_add_u32 s33, s33, 131072
    v_lshl_add_u32 v14, v62, 10, v4
    v_add_u32 v14, s33, v14
    v_or_b32 v13, 240, v14
    s_lshl_b32 s33, 1, s32
    v_mov_b32 v5, s33
    s_cmp_ge_u32 s2, 64
    s_cbranch_scc1 L_A_nobin
    s_movk_i32 s33, -40
    s_mov_b32 s34, 131072
    s_mov_b32 s35, 1032223
    s_waitcnt vmcnt(5)
    v_mul_u32_u24 v148, 52429, v128
    v_lshrrev_b32 v148, 21, v148
    v_mad_i32_i24 v128, v148, s33, v128
    v_and_b32 v179, 31, v148
    v_lshl_add_u32 v168, v148, 7, s34
    v_lshl_add_u32 v158, v179, 2, v168
    ds_add_rtn_u32 v158, v158, v3
    v_mul_u32_u24 v178, 26, v128
    v_lshrrev_b32 v178, 8, v178
    v_mad_u32_u24 v128, v178, 6, v128
    v_lshl_or_b32 v138, v128, 14, v138
    v_mul_u32_u24 v149, 52429, v129
    v_lshrrev_b32 v149, 21, v149
    v_mad_i32_i24 v129, v149, s33, v129
    v_and_b32 v179, 31, v149
    v_lshl_add_u32 v169, v149, 7, s34
    v_lshl_add_u32 v159, v179, 2, v169
    ds_add_rtn_u32 v159, v159, v3
    v_mul_u32_u24 v178, 26, v129
    v_lshrrev_b32 v178, 8, v178
    v_mad_u32_u24 v129, v178, 6, v129
    v_lshl_or_b32 v139, v129, 14, v139
    v_mul_u32_u24 v150, 52429, v130
    v_lshrrev_b32 v150, 21, v150
    v_mad_i32_i24 v130, v150, s33, v130
    v_and_b32 v179, 31, v150
    v_lshl_add_u32 v170, v150, 7, s34
    v_lshl_add_u32 v160, v179, 2, v170
    ds_add_rtn_u32 v160, v160, v3
    v_mul_u32_u24 v178, 26, v130
    v_lshrrev_b32 v178, 8, v178
    v_mad_u32_u24 v130, v178, 6, v130
    v_lshl_or_b32 v140, v130, 14, v140
    v_mul_u32_u24 v151, 52429, v131
    v_lshrrev_b32 v151, 21, v151
    v_mad_i32_i24 v131, v151, s33, v131
    v_and_b32 v179, 31, v151
    v_lshl_add_u32 v171, v151, 7, s34
    v_lshl_add_u32 v161, v179, 2, v171
    ds_add_rtn_u32 v161, v161, v3
    v_mul_u32_u24 v178, 26, v131
    v_lshrrev_b32 v178, 8, v178
    v_mad_u32_u24 v131, v178, 6, v131
    v_lshl_or_b32 v141, v131, 14, v141
    s_waitcnt vmcnt(3)
    v_mul_u32_u24 v152, 52429, v132
    v_lshrrev_b32 v152, 21, v152
    v_mad_i32_i24 v132, v152, s33, v132
    v_and_b32 v179, 31, v152
    v_lshl_add_u32 v172, v152, 7, s34
    v_lshl_add_u32 v162, v179, 2, v172
    ds_add_rtn_u32 v162, v162, v3
    v_mul_u32_u24 v178, 26, v132
    v_lshrrev_b32 v178, 8, v178
    v_mad_u32_u24 v132, v178, 6, v132
    v_lshl_or_b32 v142, v132, 14, v142
    v_mul_u32_u24 v153, 52429, v133
    v_lshrrev_b32 v153, 21, v153
    v_mad_i32_i24 v133, v153, s33, v133
    v_and_b32 v179, 31, v153
    v_lshl_add_u32 v173, v153, 7, s34
    v_lshl_add_u32 v163, v179, 2, v173
    ds_add_rtn_u32 v163, v163, v3
    v_mul_u32_u24 v178, 26, v133
    v_lshrrev_b32 v178, 8, v178
    v_mad_u32_u24 v133, v178, 6, v133
    v_lshl_or_b32 v143, v133, 14, v143
    v_mul_u32_u24 v154, 52429, v134
    v_lshrrev_b32 v154, 21, v154
    v_mad_i32_i24 v134, v154, s33, v134
    v_and_b32 v179, 31, v154
    v_lshl_add_u32 v174, v154, 7, s34
    v_lshl_add_u32 v164, v179, 2, v174
    ds_add_rtn_u32 v164, v164, v3
    v_mul_u32_u24 v178, 26, v134
    v_lshrrev_b32 v178, 8, v178
    v_mad_u32_u24 v134, v178, 6, v134
    v_lshl_or_b32 v144, v134, 14, v144
    v_mul_u32_u24 v155, 52429, v135
    v_lshrrev_b32 v155, 21, v155
    v_mad_i32_i24 v135, v155, s33, v135
    v_and_b32 v179, 31, v155
    v_lshl_add_u32 v175, v155, 7, s34
    v_lshl_add_u32 v165, v179, 2, v175
    ds_add_rtn_u32 v165, v165, v3
    v_mul_u32_u24 v178, 26, v135
    v_lshrrev_b32 v178, 8, v178
    v_mad_u32_u24 v135, v178, 6, v135
    v_lshl_or_b32 v145, v135, 14, v145
    s_waitcnt vmcnt(1)
    v_mul_u32_u24 v156, 52429, v136
    v_lshrrev_b32 v156, 21, v156
    v_mad_i32_i24 v136, v156, s33, v136
    v_and_b32 v179, 31, v156
    v_lshl_add_u32 v176, v156, 7, s34
    v_lshl_add_u32 v166, v179, 2, v176
    s_mov_b64 exec, s[96:97]
    ds_add_rtn_u32 v166, v166, v3
    v_mul_u32_u24 v178, 26, v136
    v_lshrrev_b32 v178, 8, v178
    v_mad_u32_u24 v136, v178, 6, v136
    v_lshl_or_b32 v146, v136, 14, v146
    v_mul_u32_u24 v157, 52429, v137
    v_lshrrev_b32 v157, 21, v157
    v_mad_i32_i24 v137, v157, s33, v137
    v_and_b32 v179, 31, v157
    v_lshl_add_u32 v177, v157, 7, s34
    v_lshl_add_u32 v167, v179, 2, v177
    ds_add_rtn_u32 v167, v167, v3
    v_mul_u32_u24 v178, 26, v137
    v_lshrrev_b32 v178, 8, v178
    v_mad_u32_u24 v137, v178, 6, v137
    v_lshl_or_b32 v147, v137, 14, v147
    s_mov_b64 exec, -1
    s_waitcnt lgkmcnt(9)
    v_add3_u32 v178, v148, v158, 1
    v_cmp_gt_u32 vcc, s35, v158
    v_and_b32 v178, 31, v178
    v_lshl_add_u32 v178, v178, 2, v168
    s_mov_b64 exec, vcc
    ds_write_b32 v178, v138
    s_mov_b64 exec, -1
    s_waitcnt lgkmcnt(9)
    v_add3_u32 v178, v149, v159, 1
    v_cmp_gt_u32 vcc, s35, v159
    v_and_b32 v178, 31, v178
    v_lshl_add_u32 v178, v178, 2, v169
    s_mov_b64 exec, vcc
    ds_write_b32 v178, v139
    s_mov_b64 exec, -1
    s_waitcnt lgkmcnt(9)
    v_add3_u32 v178, v150, v160, 1
    v_cmp_gt_u32 vcc, s35, v160
    v_and_b32 v178, 31, v178
    v_lshl_add_u32 v178, v178, 2, v170
    s_mov_b64 exec, vcc
    ds_write_b32 v178, v140
    s_mov_b64 exec, -1
    s_waitcnt lgkmcnt(9)
    v_add3_u32 v178, v151, v161, 1
    v_cmp_gt_u32 vcc, s35, v161
    v_and_b32 v178, 31, v178
    v_lshl_add_u32 v178, v178, 2, v171
    s_mov_b64 exec, vcc
    ds_write_b32 v178, v141
    s_mov_b64 exec, -1
    s_waitcnt lgkmcnt(9)
    v_add3_u32 v178, v152, v162, 1
    v_cmp_gt_u32 vcc, s35, v162
    v_and_b32 v178, 31, v178
    v_lshl_add_u32 v178, v178, 2, v172
    s_mov_b64 exec, vcc
    ds_write_b32 v178, v142
    s_mov_b64 exec, -1
    s_waitcnt lgkmcnt(9)
    v_add3_u32 v178, v153, v163, 1
    v_cmp_gt_u32 vcc, s35, v163
    v_and_b32 v178, 31, v178
    v_lshl_add_u32 v178, v178, 2, v173
    s_mov_b64 exec, vcc
    ds_write_b32 v178, v143
    s_mov_b64 exec, -1
    s_waitcnt lgkmcnt(9)
    v_add3_u32 v178, v154, v164, 1
    v_cmp_gt_u32 vcc, s35, v164
    v_and_b32 v178, 31, v178
    v_lshl_add_u32 v178, v178, 2, v174
    s_mov_b64 exec, vcc
    ds_write_b32 v178, v144
    s_mov_b64 exec, -1
    s_waitcnt lgkmcnt(9)
    v_add3_u32 v178, v155, v165, 1
    v_cmp_gt_u32 vcc, s35, v165
    v_and_b32 v178, 31, v178
    v_lshl_add_u32 v178, v178, 2, v175
    s_mov_b64 exec, vcc
    ds_write_b32 v178, v145
    s_mov_b64 exec, -1
    s_waitcnt lgkmcnt(9)
    v_add3_u32 v178, v156, v166, 1
    v_cmp_gt_u32 vcc, s35, v166
    v_and_b32 v178, 31, v178
    v_lshl_add_u32 v178, v178, 2, v176
    s_and_b64 exec, vcc, s[96:97]
    ds_write_b32 v178, v146
    s_mov_b64 exec, -1
    s_waitcnt lgkmcnt(9)
    v_add3_u32 v178, v157, v167, 1
    v_cmp_gt_u32 vcc, s35, v167
    v_and_b32 v178, 31, v178
    v_lshl_add_u32 v178, v178, 2, v177
    s_and_b64 exec, vcc, s[96:97]
    ds_write_b32 v178, v147
    s_mov_b64 exec, -1
    s_mov_b64 exec, 1
    ds_add_u32 v2, v3 offset:72
    s_mov_b64 exec, -1
    v_lshl_add_u32 v128, s32, 6, v1
    v_lshlrev_b32 v129, 4, v128
    v_add_u32 v129, 131072, v129
    v_lshrrev_b32 v130, 3, v128
    v_and_b32 v131, 7, v128
    v_lshlrev_b32 v130, 13, v130
    v_lshlrev_b32 v131, 4, v131
    s_lshl_b32 s33, s2, 7
    v_add3_u32 v130, v130, v131, s33
    s_waitcnt vmcnt(0)
    v_readfirstlane_b32 s34, v15
    s_lshr_b32 s34, s34, 20
    s_add_u32 s34, s34, 709
    s_lshl_b32 s34, s34, 20
L_sw_21:
    ds_read_b32 v62, v2 offset:72
    s_waitcnt lgkmcnt(0)
    v_readfirstlane_b32 s33, v62
    s_cmp_ge_u32 s33, 4
    s_cbranch_scc1 L_sd_22
    s_add_u32 s93, s93, 1
    s_cmp_lt_u32 s93, 2097152
    s_cbranch_scc1 L_sw_21
    s_endpgm
L_sd_22:
    ds_read_b128 v[64:67], v129 offset:0
    ds_read_b128 v[68:71], v129 offset:4096
    ds_read_b128 v[72:75], v129 offset:8192
    ds_read_b128 v[76:79], v129 offset:12288
    ds_read_b128 v[80:83], v129 offset:16384
    ds_read_b128 v[84:87], v129 offset:20480
    ds_read_b128 v[88:91], v129 offset:24576
    ds_read_b128 v[92:95], v129 offset:28672
    s_mov_b32 s33, 0
    s_waitcnt lgkmcnt(7)
    v_or_b32 v64, s34, v64
    v_or_b32 v65, s34, v65
    v_or_b32 v66, s34, v66
    v_or_b32 v67, s34, v67
    buffer_store_dwordx4 v[64:67], v130, s[60:63], s33 offen sc1
    s_add_u32 s33, s33, 262144
    s_waitcnt lgkmcnt(6)
    v_or_b32 v68, s34, v68
    v_or_b32 v69, s34, v69
    v_or_b32 v70, s34, v70
    v_or_b32 v71, s34, v71
    buffer_store_dwordx4 v[68:71], v130, s[60:63], s33 offen sc1
    s_add_u32 s33, s33, 262144
    s_waitcnt lgkmcnt(5)
    v_or_b32 v72, s34, v72
    v_or_b32 v73, s34, v73
    v_or_b32 v74, s34, v74
    v_or_b32 v75, s34, v75
    buffer_store_dwordx4 v[72:75], v130, s[60:63], s33 offen sc1
    s_add_u32 s33, s33, 262144
    s_waitcnt lgkmcnt(4)
    v_or_b32 v76, s34, v76
    v_or_b32 v77, s34, v77
    v_or_b32 v78, s34, v78
    v_or_b32 v79, s34, v79
    buffer_store_dwordx4 v[76:79], v130, s[60:63], s33 offen sc1
    s_add_u32 s33, s33, 262144
    s_waitcnt lgkmcnt(3)
    v_or_b32 v80, s34, v80
    v_or_b32 v81, s34, v81
    v_or_b32 v82, s34, v82
    v_or_b32 v83, s34, v83
    buffer_store_dwordx4 v[80:83], v130, s[60:63], s33 offen sc1
    s_add_u32 s33, s33, 262144
    s_waitcnt lgkmcnt(2)
    v_or_b32 v84, s34, v84
    v_or_b32 v85, s34, v85
    v_or_b32 v86, s34, v86
    v_or_b32 v87, s34, v87
    buffer_store_dwordx4 v[84:87], v130, s[60:63], s33 offen sc1
    s_add_u32 s33, s33, 262144
    s_waitcnt lgkmcnt(1)
    v_or_b32 v88, s34, v88
    v_or_b32 v89, s34, v89
    v_or_b32 v90, s34, v90
    v_or_b32 v91, s34, v91
    buffer_store_dwordx4 v[88:91], v130, s[60:63], s33 offen sc1
    s_add_u32 s33, s33, 262144
    s_waitcnt lgkmcnt(0)
    v_or_b32 v92, s34, v92
    v_or_b32 v93, s34, v93
    v_or_b32 v94, s34, v94
    v_or_b32 v95, s34, v95
    buffer_store_dwordx4 v[92:95], v130, s[60:63], s33 offen sc1
    s_mov_b64 exec, 1
    ds_add_u32 v2, v3 offset:20
    s_mov_b64 exec, -1
L_sw_23:
    ds_read_b32 v62, v2 offset:20
    s_waitcnt lgkmcnt(0)
    v_readfirstlane_b32 s33, v62
    s_cmp_ge_u32 s33, 4
    s_cbranch_scc1 L_sd_24
    s_add_u32 s93, s93, 1
    s_cmp_lt_u32 s93, 2097152
    s_cbranch_scc1 L_sw_23
    s_endpgm
L_sd_24:
    s_branch L_A_go
L_A_nobin:
    s_waitcnt vmcnt(0)
L_A_go:
    v_readfirstlane_b32 s64, v15
    s_lshr_b32 s64, s64, 20
    s_add_u32 s64, s64, 709
    s_lshl_b32 s64, s64, 20
L_sw_25:
    ds_read_b32 v62, v2 offset:0
    s_waitcnt lgkmcnt(0)
    v_readfirstlane_b32 s33, v62
    s_cmp_ge_u32 s33, 4
    s_cbranch_scc1 L_sd_26
    s_add_u32 s93, s93, 1
    s_cmp_lt_u32 s93, 2097152
    s_cbranch_scc1 L_sw_25
    s_endpgm
L_sd_26:
    v_lshlrev_b32 v36, 4, v1
    s_mul_i32 s33, s32, 5120
    s_add_u32 s34, s33, 106752
    s_add_u32 m0, s34, 0
    s_nop 0
    buffer_load_dwordx4 v36, s[56:59], s33 offen lds
    s_add_u32 s33, s33, 1024
    s_add_u32 m0, s34, 1024
    s_nop 0
    buffer_load_dwordx4 v36, s[56:59], s33 offen lds
    s_add_u32 s33, s33, 1024
    s_add_u32 m0, s34, 2048
    s_nop 0
    buffer_load_dwordx4 v36, s[56:59], s33 offen lds
    s_add_u32 s33, s33, 1024
    s_add_u32 m0, s34, 3072
    s_nop 0
    buffer_load_dwordx4 v36, s[56:59], s33 offen lds
    s_add_u32 s33, s33, 1024
    s_add_u32 m0, s34, 4096
    s_nop 0
    buffer_load_dwordx4 v36, s[56:59], s33 offen lds
    s_cmp_lg_u32 s32, 0
    s_cbranch_scc1 L_A_noflag
    s_or_b32 s33, s64, 370085
    s_lshl_b32 s34, s2, 2
    v_mov_b32 v62, s33
    v_mov_b32 v63, s34
    s_mov_b64 exec, 1
    global_store_dword v63, v62, s[28:29] offset:1024 sc1
    s_mov_b64 exec, -1
L_A_noflag:
    s_call_b64 s[30:31], L_init
    v_mov_b32 v160, 0
    v_mov_b32 v161, 0
    v_mov_b32 v162, 0
    v_mov_b32 v163, 0
    v_mov_b32 v164, 0
    v_mov_b32 v165, 0
    v_mov_b32 v166, 0
    v_mov_b32 v167, 0
    v_mov_b32 v168, 0
    v_mov_b32 v169, 0
    v_mov_b32 v170, 0
    v_mov_b32 v171, 0
    v_mov_b32 v172, 0
    v_mov_b32 v173, 0
    v_mov_b32 v174, 0
    v_mov_b32 v175, 0
    v_mov_b32 v176, 0
    v_mov_b32 v177, 0
    v_mov_b32 v178, 0
    v_mov_b32 v179, 0
    v_mov_b32 v180, 0
    v_mov_b32 v181, 0
    v_mov_b32 v182, 0
    v_mov_b32 v183, 0
    v_mov_b32 v184, 0
    v_mov_b32 v185, 0
    v_mov_b32 v186, 0
    v_mov_b32 v187, 0
    v_mov_b32 v188, 0
    v_mov_b32 v189, 0
    v_mov_b32 v190, 0
    v_mov_b32 v191, 0
    s_lshl_b32 s33, s32, 11
    s_lshl_b32 s34, s2, 13
    s_add_u32 s33, s33, s34
    v_lshlrev_b32 v15, 4, v1
    v_add_u32 v15, s33, v15
    s_waitcnt vmcnt(0)
    s_mov_b64 exec, 1
    ds_add_u32 v2, v3 offset:24
    s_mov_b64 exec, -1
L_sw_27:
    ds_read_b32 v62, v2 offset:60
    s_waitcnt lgkmcnt(0)
    v_readfirstlane_b32 s33, v62
    s_cmp_ge_u32 s33, 4
    s_cbranch_scc1 L_sd_28
    s_add_u32 s93, s93, 1
    s_cmp_lt_u32 s93, 2097152
    s_cbranch_scc1 L_sw_27
    s_endpgm
L_sd_28:
L_poll:
    buffer_load_dwordx4 v[44:47], v15, s[60:63], 0 offen sc1
    buffer_load_dwordx4 v[48:51], v15, s[60:63], 0 offen offset:1024 sc1
    s_waitcnt vmcnt(0)
    v_xor_b32 v44, s64, v44
    v_xor_b32 v45, s64, v45
    v_xor_b32 v46, s64, v46
    v_xor_b32 v47, s64, v47
    v_xor_b32 v48, s64, v48
    v_xor_b32 v49, s64, v49
    v_xor_b32 v50, s64, v50
    v_xor_b32 v51, s64, v51
    v_max3_u32 v62, v44, v45, v46
    v_max3_u32 v63, v47, v48, v49
    v_max3_u32 v62, v62, v50, v51
    v_max_u32 v62, v62, v63
    v_cmp_lt_u32 vcc, 0xfffff, v62
    s_cmp_eq_u64 vcc, 0
    s_cbranch_scc1 L_got
    s_add_u32 s93, s93, 16
    s_cmp_ge_u32 s93, 2097152
    s_cbranch_scc1 L_end
    s_sleep 4
    s_branch L_poll
L_got:
L_sw_29:
    ds_read_b32 v63, v2 offset:24
    s_waitcnt lgkmcnt(0)
    v_readfirstlane_b32 s33, v63
    s_cmp_ge_u32 s33, 4
    s_cbranch_scc1 L_sd_30
    s_add_u32 s93, s93, 1
    s_cmp_lt_u32 s93, 2097152
    s_cbranch_scc1 L_sw_29
    s_endpgm
L_sd_30:
    ds_read_u16 v12, v12
    v_cmp_lt_u32 vcc, 1032223, v62
    s_cmp_lg_u64 vcc, 0
    s_cselect_b32 s35, 0x10000, 0
L_round:
    s_mov_b32 s33, 1032192
    v_and_b32 v128, 16383, v44
    v_cmp_gt_u32 s[72:73], s33, v44
    v_lshl_add_u32 v192, v128, 1, s88
    v_lshrrev_b32 v144, 15, v44
    ds_read_u16 v192, v192
    v_and_b32 v144, 0x18, v144
    v_lshlrev_b32 v62, v144, v3
    v_lshrrev_b32 v136, 10, v44
    v_cndmask_b32_e64 v62, 0, v62, s[72:73]
    s_bcnt1_i32_b64 s34, s[72:73]
    s_add_u32 s35, s35, s34
    v_add_u32 v153, v2, v62
    v_and_b32 v129, 16383, v45
    v_cmp_gt_u32 s[74:75], s33, v45
    v_lshl_add_u32 v193, v129, 1, s88
    v_lshrrev_b32 v145, 15, v45
    ds_read_u16 v193, v193
    v_and_b32 v145, 0x18, v145
    v_lshlrev_b32 v62, v145, v3
    v_lshrrev_b32 v137, 10, v45
    v_cndmask_b32_e64 v62, 0, v62, s[74:75]
    s_bcnt1_i32_b64 s34, s[74:75]
    s_add_u32 s35, s35, s34
    v_add_u32 v154, v153, v62
    v_and_b32 v130, 16383, v46
    v_cmp_gt_u32 s[76:77], s33, v46
    v_lshl_add_u32 v194, v130, 1, s88
    v_lshrrev_b32 v146, 15, v46
    ds_read_u16 v194, v194
    v_and_b32 v146, 0x18, v146
    v_lshlrev_b32 v62, v146, v3
    v_lshrrev_b32 v138, 10, v46
    v_cndmask_b32_e64 v62, 0, v62, s[76:77]
    s_bcnt1_i32_b64 s34, s[76:77]
    s_add_u32 s35, s35, s34
    v_add_u32 v155, v154, v62
    v_and_b32 v131, 16383, v47
    v_cmp_gt_u32 s[78:79], s33, v47
    v_lshl_add_u32 v195, v131, 1, s88
    v_lshrrev_b32 v147, 15, v47
    ds_read_u16 v195, v195
    v_and_b32 v147, 0x18, v147
    v_lshlrev_b32 v62, v147, v3
    v_lshrrev_b32 v139, 10, v47
    v_cndmask_b32_e64 v62, 0, v62, s[78:79]
    s_bcnt1_i32_b64 s34, s[78:79]
    s_add_u32 s35, s35, s34
    v_add_u32 v156, v155, v62
    v_and_b32 v132, 16383, v48
    v_cmp_gt_u32 s[80:81], s33, v48
    v_lshl_add_u32 v196, v132, 1, s88
    v_lshrrev_b32 v148, 15, v48
    ds_read_u16 v196, v196
    v_and_b32 v148, 0x18, v148
    v_lshlrev_b32 v62, v148, v3
    v_lshrrev_b32 v140, 10, v48
    v_cndmask_b32_e64 v62, 0, v62, s[80:81]
    s_bcnt1_i32_b64 s34, s[80:81]
    s_add_u32 s35, s35, s34
    v_add_u32 v157, v156, v62
    v_and_b32 v133, 16383, v49
    v_cmp_gt_u32 s[82:83], s33, v49
    v_lshl_add_u32 v197, v133, 1, s88
    v_lshrrev_b32 v149, 15, v49
    ds_read_u16 v197, v197
    v_and_b32 v149, 0x18, v149
    v_lshlrev_b32 v62, v149, v3
    v_lshrrev_b32 v141, 10, v49
    v_cndmask_b32_e64 v62, 0, v62, s[82:83]
    s_bcnt1_i32_b64 s34, s[82:83]
    s_add_u32 s35, s35, s34
    v_add_u32 v158, v157, v62
    v_and_b32 v134, 16383, v50
    v_cmp_gt_u32 s[84:85], s33, v50
    v_lshl_add_u32 v198, v134, 1, s88
    v_lshrrev_b32 v150, 15, v50
    ds_read_u16 v198, v198
    v_and_b32 v150, 0x18, v150
    v_lshlrev_b32 v62, v150, v3
    v_lshrrev_b32 v142, 10, v50
    v_cndmask_b32_e64 v62, 0, v62, s[84:85]
    s_bcnt1_i32_b64 s34, s[84:85]
    s_add_u32 s35, s35, s34
    v_add_u32 v159, v158, v62
    v_and_b32 v135, 16383, v51
    v_cmp_gt_u32 s[86:87], s33, v51
    v_lshl_add_u32 v199, v135, 1, s88
    v_lshrrev_b32 v151, 15, v51
    ds_read_u16 v199, v199
    v_and_b32 v151, 0x18, v151
    v_lshlrev_b32 v62, v151, v3
    v_lshrrev_b32 v143, 10, v51
    v_cndmask_b32_e64 v62, 0, v62, s[86:87]
    s_bcnt1_i32_b64 s34, s[86:87]
    s_add_u32 s35, s35, s34
    v_add_u32 v54, v159, v62
    v_mov_b32 v62, v54
    v_mov_b32 v52, 0x3f0
    v_and_or_b32 v136, v136, v52, s89
    v_and_or_b32 v137, v137, v52, s89
    v_add_u32_dpp v62, v62, v62 row_shr:1 row_mask:0xf bank_mask:0xf
    v_and_or_b32 v138, v138, v52, s89
    v_and_or_b32 v139, v139, v52, s89
    v_add_u32_dpp v62, v62, v62 row_shr:2 row_mask:0xf bank_mask:0xf
    v_and_or_b32 v140, v140, v52, s89
    v_and_or_b32 v141, v141, v52, s89
    v_add_u32_dpp v62, v62, v62 row_shr:4 row_mask:0xf bank_mask:0xf
    v_and_or_b32 v142, v142, v52, s89
    v_and_or_b32 v143, v143, v52, s89
    v_add_u32_dpp v62, v62, v62 row_shr:8 row_mask:0xf bank_mask:0xf
    s_nop 1
    v_add_u32_dpp v62, v62, v62 row_bcast:15 row_mask:0xa bank_mask:0xf
    s_nop 1
    v_add_u32_dpp v62, v62, v62 row_bcast:31 row_mask:0xc bank_mask:0xf
    s_and_b32 s34, s71, 4
    s_lshl_b32 s34, s34, 1
    v_mov_b32 v63, s34
    v_readlane_b32 s33, v62, 63
    v_mov_b32 v57, s35
    v_sub_u32 v62, v62, v54
    v_mov_b32 v56, s33
    s_mov_b64 exec, 1
    ds_add_rtn_u64 v[56:57], v63, v[56:57] offset:32
    s_mov_b64 exec, -1
    v_mov_b32 v152, 0
    s_add_u32 s71, s71, 4
    s_waitcnt lgkmcnt(0)
    v_readfirstlane_b32 s33, v56
    s_nop 1
    v_add_u32 v62, s33, v62
    v_add_u32 v152, v152, v62
    v_bfe_u32 v152, v152, v144, 8
    v_lshlrev_b32 v144, 7, v152
    v_lshlrev_b32 v52, 10, v152
    v_and_or_b32 v136, v144, s99, v136
    v_lshrrev_b32 v152, 1, v152
    v_and_or_b32 v136, v52, s53, v136
    v_and_or_b32 v136, v152, 14, v136
    s_mov_b64 exec, s[72:73]
    v_or_b32 v144, 240, v136
    ds_write_b16 v136, v192
    ds_write_b16 v144, v128
    s_mov_b64 exec, -1
    v_add_u32 v153, v153, v62
    v_bfe_u32 v153, v153, v145, 8
    v_lshlrev_b32 v145, 7, v153
    v_lshlrev_b32 v52, 10, v153
    v_and_or_b32 v137, v145, s99, v137
    v_lshrrev_b32 v153, 1, v153
    v_and_or_b32 v137, v52, s53, v137
    v_and_or_b32 v137, v153, 14, v137
    s_mov_b64 exec, s[74:75]
    v_or_b32 v145, 240, v137
    ds_write_b16 v137, v193
    ds_write_b16 v145, v129
    s_mov_b64 exec, -1
    v_add_u32 v154, v154, v62
    v_bfe_u32 v154, v154, v146, 8
    v_lshlrev_b32 v146, 7, v154
    v_lshlrev_b32 v52, 10, v154
    v_and_or_b32 v138, v146, s99, v138
    v_lshrrev_b32 v154, 1, v154
    v_and_or_b32 v138, v52, s53, v138
    v_and_or_b32 v138, v154, 14, v138
    s_mov_b64 exec, s[76:77]
    v_or_b32 v146, 240, v138
    ds_write_b16 v138, v194
    ds_write_b16 v146, v130
    s_mov_b64 exec, -1
    v_add_u32 v155, v155, v62
    v_bfe_u32 v155, v155, v147, 8
    v_lshlrev_b32 v147, 7, v155
    v_lshlrev_b32 v52, 10, v155
    v_and_or_b32 v139, v147, s99, v139
    v_lshrrev_b32 v155, 1, v155
    v_and_or_b32 v139, v52, s53, v139
    v_and_or_b32 v139, v155, 14, v139
    s_mov_b64 exec, s[78:79]
    v_or_b32 v147, 240, v139
    ds_write_b16 v139, v195
    ds_write_b16 v147, v131
    s_mov_b64 exec, -1
    v_add_u32 v156, v156, v62
    v_bfe_u32 v156, v156, v148, 8
    v_lshlrev_b32 v148, 7, v156
    v_lshlrev_b32 v52, 10, v156
    v_and_or_b32 v140, v148, s99, v140
    v_lshrrev_b32 v156, 1, v156
    v_and_or_b32 v140, v52, s53, v140
    v_and_or_b32 v140, v156, 14, v140
    s_mov_b64 exec, s[80:81]
    v_or_b32 v148, 240, v140
    ds_write_b16 v140, v196
    ds_write_b16 v148, v132
    s_mov_b64 exec, -1
    v_add_u32 v157, v157, v62
    v_bfe_u32 v157, v157, v149, 8
    v_lshlrev_b32 v149, 7, v157
    v_lshlrev_b32 v52, 10, v157
    v_and_or_b32 v141, v149, s99, v141
    v_lshrrev_b32 v157, 1, v157
    v_and_or_b32 v141, v52, s53, v141
    v_and_or_b32 v141, v157, 14, v141
    s_mov_b64 exec, s[82:83]
    v_or_b32 v149, 240, v141
    ds_write_b16 v141, v197
    ds_write_b16 v149, v133
    s_mov_b64 exec, -1
    v_add_u32 v158, v158, v62
    v_bfe_u32 v158, v158, v150, 8
    v_lshlrev_b32 v150, 7, v158
    v_lshlrev_b32 v52, 10, v158
    v_and_or_b32 v142, v150, s99, v142
    v_lshrrev_b32 v158, 1, v158
    v_and_or_b32 v142, v52, s53, v142
    v_and_or_b32 v142, v158, 14, v142
    s_mov_b64 exec, s[84:85]
    v_or_b32 v150, 240, v142
    ds_write_b16 v142, v198
    ds_write_b16 v150, v134
    s_mov_b64 exec, -1
    v_add_u32 v159, v159, v62
    v_bfe_u32 v159, v159, v151, 8
    v_lshlrev_b32 v151, 7, v159
    v_lshlrev_b32 v52, 10, v159
    v_and_or_b32 v143, v151, s99, v143
    v_lshrrev_b32 v159, 1, v159
    v_and_or_b32 v143, v52, s53, v143
    v_and_or_b32 v143, v159, 14, v143
    s_mov_b64 exec, s[86:87]
    v_or_b32 v151, 240, v143
    ds_write_b16 v143, v199
    ds_write_b16 v151, v135
    s_mov_b64 exec, -1
    s_mov_b64 exec, 1
    ds_add_u32 v2, v3 offset:28
    s_mov_b64 exec, -1
L_sw_31:
    ds_read_b32 v54, v2 offset:28
    s_waitcnt lgkmcnt(0)
    v_readfirstlane_b32 s33, v54
    s_cmp_ge_u32 s33, s71
    s_cbranch_scc1 L_sd_32
    s_add_u32 s93, s93, 1
    s_cmp_lt_u32 s93, 2097152
    s_cbranch_scc1 L_sw_31
    s_endpgm
L_sd_32:
    ds_read_b64 v[56:57], v63 offset:32
    s_lshl_b32 s35, s32, 3
    s_waitcnt lgkmcnt(0)
    v_sad_u8 v62, v56, 0, 0
    v_readfirstlane_b32 s66, v56
    v_cmp_ne_u32 vcc, v62, v57
    s_lshr_b32 s66, s66, s35
    s_and_b32 s66, s66, 255
    s_and_b32 s65, vcc_lo, 1
    s_cbranch_scc1 L_slow_enter
    s_cmp_eq_u32 s66, 0
    s_cbranch_scc1 L_empty
    s_lshr_b32 s54, s66, 5
    s_and_b32 s66, s66, 31
    s_cmp_gt_u32 s66, 16
    s_addc_u32 s34, s54, 0
    s_add_u32 s70, s54, s34
    s_sub_u32 s70, s70, 1
    s_sub_u32 s94, s54, 1
    s_sub_u32 s55, s34, 1
    s_lshl_b32 s55, s55, 12
    s_lshl_b32 s35, s54, 12
    v_add_u32 v62, s35, v13
    v_add_u32 v63, s35, v14
    s_sub_u32 s35, s35, 4096
    s_cmp_eq_u32 s54, 0
    s_cselect_b32 s35, 0, s35
    v_add_u32 v13, s35, v13
    v_add_u32 v14, s35, v14
    ds_read_b128 v[36:39], v62
    ds_read_b128 v[32:35], v63
    s_lshr_b32 s95, s54, 8
    s_lshr_b32 s100, s54, 8
    ds_read_b128 v[24:27], v13
    s_add_u32 s95, s95, 1
    s_cmp_eq_u32 s95, s54
    s_cselect_b32 s33, s55, 0xfffff000
    v_add_u32 v13, s33, v13
    ds_read_b128 v[44:47], v13
    s_add_u32 s95, s95, 1
    s_cmp_eq_u32 s95, s54
    s_cselect_b32 s33, s55, 0xfffff000
    v_add_u32 v13, s33, v13
    ds_read_b128 v[52:55], v13
    s_add_u32 s95, s95, 1
    s_cmp_eq_u32 s95, s54
    s_cselect_b32 s33, s55, 0xfffff000
    v_add_u32 v13, s33, v13
    ds_read_b128 v[28:31], v14
    s_add_u32 s100, s100, 1
    s_cmp_eq_u32 s100, s54
    s_cselect_b32 s33, s55, 0xfffff000
    v_add_u32 v14, s33, v14
    s_waitcnt lgkmcnt(5)
    v_mad_u32_u16 v16, v36, s98, v4
    v_mad_u32_u16 v17, v36, s98, v4 op_sel:[1,0,0,0]
    v_mad_u32_u16 v18, v37, s98, v4
    v_mad_u32_u16 v19, v37, s98, v4 op_sel:[1,0,0,0]
    v_mad_u32_u16 v20, v38, s98, v4
    v_mad_u32_u16 v21, v38, s98, v4 op_sel:[1,0,0,0]
    v_mad_u32_u16 v22, v39, s98, v4
    v_mad_u32_u16 v23, v39, s98, v4 op_sel:[1,0,0,0]
    s_cmp_eq_u32 s66, 0
    s_cbranch_scc1 L_part
    s_sub_u32 s34, s66, 1
    s_lshr_b32 s34, s34, 2
    s_cmp_gt_u32 s66, 16
    s_cbranch_scc1 L_part8
    buffer_load_dwordx4 v[160:163], v16, s[36:39], 0 offen
    buffer_load_dwordx4 v[176:179], v16, s[36:39], 0 offen offset:256
    s_cmp_eq_u32 s34, 0
    s_cbranch_scc1 L_part
    buffer_load_dwordx4 v[164:167], v17, s[36:39], 0 offen
    buffer_load_dwordx4 v[180:183], v17, s[36:39], 0 offen offset:256
    s_cmp_eq_u32 s34, 1
    s_cbranch_scc1 L_part
    buffer_load_dwordx4 v[168:171], v18, s[36:39], 0 offen
    buffer_load_dwordx4 v[184:187], v18, s[36:39], 0 offen offset:256
    s_cmp_eq_u32 s34, 2
    s_cbranch_scc1 L_part
    buffer_load_dwordx4 v[172:175], v19, s[36:39], 0 offen
    buffer_load_dwordx4 v[188:191], v19, s[36:39], 0 offen offset:256
    s_branch L_part
L_part8:
    buffer_load_dwordx4 v[160:163], v16, s[36:39], 0 offen
    buffer_load_dwordx4 v[164:167], v17, s[36:39], 0 offen
    buffer_load_dwordx4 v[168:171], v18, s[36:39], 0 offen
    buffer_load_dwordx4 v[172:175], v19, s[36:39], 0 offen
    buffer_load_dwordx4 v[176:179], v20, s[36:39], 0 offen
    s_cmp_eq_u32 s34, 4
    s_cbranch_scc1 L_part
    buffer_load_dwordx4 v[180:183], v21, s[36:39], 0 offen
    s_cmp_eq_u32 s34, 5
    s_cbranch_scc1 L_part
    buffer_load_dwordx4 v[184:187], v22, s[36:39], 0 offen
    s_cmp_eq_u32 s34, 6
    s_cbranch_scc1 L_part
    buffer_load_dwordx4 v[188:191], v23, s[36:39], 0 offen
L_part:
    s_cmp_lt_i32 s70, 0
    s_cbranch_scc1 L_one
    s_cmp_ge_u32 0, s54
    s_cselect_b32 s101, 256, 0
    s_waitcnt lgkmcnt(3)
    v_mad_u32_u16 v16, v24, s98, v4
    v_mad_u32_u16 v17, v24, s98, v4 op_sel:[1,0,0,0]
    v_mad_u32_u16 v18, v25, s98, v4
    v_mad_u32_u16 v19, v25, s98, v4 op_sel:[1,0,0,0]
    v_mad_u32_u16 v20, v26, s98, v4
    v_mad_u32_u16 v21, v26, s98, v4 op_sel:[1,0,0,0]
    v_mad_u32_u16 v22, v27, s98, v4
    v_mad_u32_u16 v23, v27, s98, v4 op_sel:[1,0,0,0]
    ds_read_b128 v[24:27], v13
    s_add_u32 s95, s95, 1
    s_cmp_eq_u32 s95, s54
    s_cselect_b32 s33, s55, 0xfffff000
    v_add_u32 v13, s33, v13
    buffer_load_dwordx4 v[224:227], v16, s[36:39], s101 offen
    buffer_load_dwordx4 v[228:231], v17, s[36:39], s101 offen
    buffer_load_dwordx4 v[232:235], v18, s[36:39], s101 offen
    buffer_load_dwordx4 v[236:239], v19, s[36:39], s101 offen
    buffer_load_dwordx4 v[240:243], v20, s[36:39], s101 offen
    buffer_load_dwordx4 v[244:247], v21, s[36:39], s101 offen
    buffer_load_dwordx4 v[248:251], v22, s[36:39], s101 offen
    buffer_load_dwordx4 v[252:255], v23, s[36:39], s101 offen
    s_cmp_lt_i32 s70, 1
    s_cbranch_scc1 L_one
    s_cmp_ge_u32 1, s54
    s_cselect_b32 s101, 256, 0
    s_waitcnt lgkmcnt(2)
    v_mad_u32_u16 v16, v44, s98, v4
    v_mad_u32_u16 v17, v44, s98, v4 op_sel:[1,0,0,0]
    v_mad_u32_u16 v18, v45, s98, v4
    v_mad_u32_u16 v19, v45, s98, v4 op_sel:[1,0,0,0]
    v_mad_u32_u16 v20, v46, s98, v4
    v_mad_u32_u16 v21, v46, s98, v4 op_sel:[1,0,0,0]
    v_mad_u32_u16 v22, v47, s98, v4
    v_mad_u32_u16 v23, v47, s98, v4 op_sel:[1,0,0,0]
    buffer_load_dwordx4 v[192:195], v16, s[36:39], s101 offen
    buffer_load_dwordx4 v[196:199], v17, s[36:39], s101 offen
    buffer_load_dwordx4 v[200:203], v18, s[36:39], s101 offen
    buffer_load_dwordx4 v[204:207], v19, s[36:39], s101 offen
    buffer_load_dwordx4 v[208:211], v20, s[36:39], s101 offen
    buffer_load_dwordx4 v[212:215], v21, s[36:39], s101 offen
    buffer_load_dwordx4 v[216:219], v22, s[36:39], s101 offen
    buffer_load_dwordx4 v[220:223], v23, s[36:39], s101 offen
    s_cmp_lt_i32 s70, 2
    s_cbranch_scc1 L_one
    s_cmp_ge_u32 2, s54
    s_cselect_b32 s101, 256, 0
    s_waitcnt lgkmcnt(1)
    v_mad_u32_u16 v16, v52, s98, v4
    v_mad_u32_u16 v17, v52, s98, v4 op_sel:[1,0,0,0]
    v_mad_u32_u16 v18, v53, s98, v4
    v_mad_u32_u16 v19, v53, s98, v4 op_sel:[1,0,0,0]
    v_mad_u32_u16 v20, v54, s98, v4
    v_mad_u32_u16 v21, v54, s98, v4 op_sel:[1,0,0,0]
    v_mad_u32_u16 v22, v55, s98, v4
    v_mad_u32_u16 v23, v55, s98, v4 op_sel:[1,0,0,0]
    buffer_load_dwordx4 v[128:131], v16, s[36:39], s101 offen
    buffer_load_dwordx4 v[132:135], v17, s[36:39], s101 offen
    buffer_load_dwordx4 v[136:139], v18, s[36:39], s101 offen
    buffer_load_dwordx4 v[140:143], v19, s[36:39], s101 offen
    buffer_load_dwordx4 v[144:147], v20, s[36:39], s101 offen
    buffer_load_dwordx4 v[148:151], v21, s[36:39], s101 offen
    buffer_load_dwordx4 v[152:155], v22, s[36:39], s101 offen
    buffer_load_dwordx4 v[156:159], v23, s[36:39], s101 offen
L_one:
    s_setprio 0
    s_cmp_lg_u32 s67, 0
    s_cbranch_scc1 L_nozero
    v_mov_b32 v64, 0
    v_mov_b32 v65, 0
    v_mov_b32 v66, 0
    v_mov_b32 v67, 0
    v_mov_b32 v68, 0
    v_mov_b32 v69, 0
    v_mov_b32 v70, 0
    v_mov_b32 v71, 0
    v_mov_b32 v72, 0
    v_mov_b32 v73, 0
    v_mov_b32 v74, 0
    v_mov_b32 v75, 0
    v_mov_b32 v76, 0
    v_mov_b32 v77, 0
    v_mov_b32 v78, 0
    v_mov_b32 v79, 0
    v_mov_b32 v80, 0
    v_mov_b32 v81, 0
    v_mov_b32 v82, 0
    v_mov_b32 v83, 0
    v_mov_b32 v84, 0
    v_mov_b32 v85, 0
    v_mov_b32 v86, 0
    v_mov_b32 v87, 0
    v_mov_b32 v88, 0
    v_mov_b32 v89, 0
    v_mov_b32 v90, 0
    v_mov_b32 v91, 0
    v_mov_b32 v92, 0
    v_mov_b32 v93, 0
    v_mov_b32 v94, 0
    v_mov_b32 v95, 0
    v_mov_b32 v96, 0
    v_mov_b32 v97, 0
    v_mov_b32 v98, 0
    v_mov_b32 v99, 0
    v_mov_b32 v100, 0
    v_mov_b32 v101, 0
    v_mov_b32 v102, 0
    v_mov_b32 v103, 0
    v_mov_b32 v104, 0
    v_mov_b32 v105, 0
    v_mov_b32 v106, 0
    v_mov_b32 v107, 0
    v_mov_b32 v108, 0
    v_mov_b32 v109, 0
    v_mov_b32 v110, 0
    v_mov_b32 v111, 0
    v_mov_b32 v112, 0
    v_mov_b32 v113, 0
    v_mov_b32 v114, 0
    v_mov_b32 v115, 0
    v_mov_b32 v116, 0
    v_mov_b32 v117, 0
    v_mov_b32 v118, 0
    v_mov_b32 v119, 0
    v_mov_b32 v120, 0
    v_mov_b32 v121, 0
    v_mov_b32 v122, 0
    v_mov_b32 v123, 0
    v_mov_b32 v124, 0
    v_mov_b32 v125, 0
    v_mov_b32 v126, 0
    v_mov_b32 v127, 0
L_nozero:
    s_cmp_eq_u32 s66, 0
    s_cbranch_scc1 L_rem_done
    s_waitcnt vmcnt(24) lgkmcnt(0)
    s_cmp_ge_i32 s70, 2
    s_cbranch_scc1 L_rem
    s_cmp_eq_u32 s70, 1
    s_waitcnt vmcnt(16)
    s_cbranch_scc1 L_rem
    s_cmp_eq_u32 s70, 0
    s_waitcnt vmcnt(8)
    s_cbranch_scc1 L_rem
    s_waitcnt vmcnt(0)
L_rem:
    s_cmp_gt_u32 s66, 16
    s_cbranch_scc1 L_rem8
    v_perm_b32 v36, v164, v160, s68
    v_perm_b32 v37, v172, v168, s68
    v_perm_b32 v38, v164, v160, s69
    v_perm_b32 v39, v172, v168, s69
    v_perm_b32 v40, v165, v161, s68
    v_perm_b32 v41, v173, v169, s68
    v_mfma_f32_16x16x16_bf16 v[64:67], v[36:37], v[32:33], v[64:67]
    v_perm_b32 v42, v165, v161, s69
    v_perm_b32 v43, v173, v169, s69
    v_mfma_f32_16x16x16_bf16 v[68:71], v[38:39], v[32:33], v[68:71]
    v_perm_b32 v36, v166, v162, s68
    v_perm_b32 v37, v174, v170, s68
    v_mfma_f32_16x16x16_bf16 v[72:75], v[40:41], v[32:33], v[72:75]
    v_perm_b32 v38, v166, v162, s69
    v_perm_b32 v39, v174, v170, s69
    v_mfma_f32_16x16x16_bf16 v[76:79], v[42:43], v[32:33], v[76:79]
    v_perm_b32 v40, v167, v163, s68
    v_perm_b32 v41, v175, v171, s68
    v_mfma_f32_16x16x16_bf16 v[80:83], v[36:37], v[32:33], v[80:83]
    v_perm_b32 v42, v167, v163, s69
    v_perm_b32 v43, v175, v171, s69
    v_mfma_f32_16x16x16_bf16 v[84:87], v[38:39], v[32:33], v[84:87]
    v_perm_b32 v36, v180, v176, s68
    v_perm_b32 v37, v188, v184, s68
    v_mfma_f32_16x16x16_bf16 v[88:91], v[40:41], v[32:33], v[88:91]
    v_perm_b32 v38, v180, v176, s69
    v_perm_b32 v39, v188, v184, s69
    v_mfma_f32_16x16x16_bf16 v[92:95], v[42:43], v[32:33], v[92:95]
    v_perm_b32 v40, v181, v177, s68
    v_perm_b32 v41, v189, v185, s68
    v_mfma_f32_16x16x16_bf16 v[96:99], v[36:37], v[32:33], v[96:99]
    v_perm_b32 v42, v181, v177, s69
    v_perm_b32 v43, v189, v185, s69
    v_mfma_f32_16x16x16_bf16 v[100:103], v[38:39], v[32:33], v[100:103]
    v_perm_b32 v36, v182, v178, s68
    v_perm_b32 v37, v190, v186, s68
    v_mfma_f32_16x16x16_bf16 v[104:107], v[40:41], v[32:33], v[104:107]
    v_perm_b32 v38, v182, v178, s69
    v_perm_b32 v39, v190, v186, s69
    v_mfma_f32_16x16x16_bf16 v[108:111], v[42:43], v[32:33], v[108:111]
    v_perm_b32 v40, v183, v179, s68
    v_perm_b32 v41, v191, v187, s68
    v_mfma_f32_16x16x16_bf16 v[112:115], v[36:37], v[32:33], v[112:115]
    v_perm_b32 v42, v183, v179, s69
    v_perm_b32 v43, v191, v187, s69
    v_mfma_f32_16x16x16_bf16 v[116:119], v[38:39], v[32:33], v[116:119]
    v_mfma_f32_16x16x16_bf16 v[120:123], v[40:41], v[32:33], v[120:123]
    v_mfma_f32_16x16x16_bf16 v[124:127], v[42:43], v[32:33], v[124:127]
    s_branch L_rem_done
L_rem8:
    v_perm_b32 v36, v164, v160, s68
    v_perm_b32 v37, v172, v168, s68
    v_perm_b32 v38, v180, v176, s68
    v_perm_b32 v39, v188, v184, s68
    v_perm_b32 v40, v164, v160, s69
    v_perm_b32 v41, v172, v168, s69
    v_perm_b32 v42, v180, v176, s69
    v_perm_b32 v43, v188, v184, s69
    v_mfma_f32_16x16x32_bf16 v[64:67], v[36:39], v[32:35], v[64:67]
    v_perm_b32 v36, v165, v161, s68
    v_perm_b32 v37, v173, v169, s68
    v_perm_b32 v38, v181, v177, s68
    v_perm_b32 v39, v189, v185, s68
    v_mfma_f32_16x16x32_bf16 v[68:71], v[40:43], v[32:35], v[68:71]
    v_perm_b32 v40, v165, v161, s69
    v_perm_b32 v41, v173, v169, s69
    v_perm_b32 v42, v181, v177, s69
    v_perm_b32 v43, v189, v185, s69
    v_mfma_f32_16x16x32_bf16 v[72:75], v[36:39], v[32:35], v[72:75]
    v_perm_b32 v36, v166, v162, s68
    v_perm_b32 v37, v174, v170, s68
    v_perm_b32 v38, v182, v178, s68
    v_perm_b32 v39, v190, v186, s68
    v_mfma_f32_16x16x32_bf16 v[76:79], v[40:43], v[32:35], v[76:79]
    v_perm_b32 v40, v166, v162, s69
    v_perm_b32 v41, v174, v170, s69
    v_perm_b32 v42, v182, v178, s69
    v_perm_b32 v43, v190, v186, s69
    v_mfma_f32_16x16x32_bf16 v[80:83], v[36:39], v[32:35], v[80:83]
    v_perm_b32 v36, v167, v163, s68
    v_perm_b32 v37, v175, v171, s68
    v_perm_b32 v38, v183, v179, s68
    v_perm_b32 v39, v191, v187, s68
    v_mfma_f32_16x16x32_bf16 v[84:87], v[40:43], v[32:35], v[84:87]
    v_perm_b32 v40, v167, v163, s69
    v_perm_b32 v41, v175, v171, s69
    v_perm_b32 v42, v183, v179, s69
    v_perm_b32 v43, v191, v187, s69
    v_mfma_f32_16x16x32_bf16 v[88:91], v[36:39], v[32:35], v[88:91]
    s_nop 0
    v_mfma_f32_16x16x32_bf16 v[92:95], v[40:43], v[32:35], v[92:95]
L_rem_done:
    s_cmp_lg_u32 s54, 0
    s_cbranch_scc1 L_rem_go
    s_call_b64 s[30:31], L_half
L_rem_go:
    s_cmp_lt_i32 s70, 0
    s_cbranch_scc1 L_round_end
L_agg:
    s_cmp_lt_u32 s70, 3
    s_waitcnt vmcnt(16) lgkmcnt(0)
    s_cbranch_scc1 L_a_33
    s_cmp_gt_u32 s95, s54
    s_cselect_b32 s101, 256, 0
    v_mad_u32_u16 v16, v24, s98, v4
    v_mad_u32_u16 v17, v24, s98, v4 op_sel:[1,0,0,0]
    v_mad_u32_u16 v18, v25, s98, v4
    v_mad_u32_u16 v19, v25, s98, v4 op_sel:[1,0,0,0]
    v_mad_u32_u16 v20, v26, s98, v4
    v_mad_u32_u16 v21, v26, s98, v4 op_sel:[1,0,0,0]
    v_mad_u32_u16 v22, v27, s98, v4
    v_mad_u32_u16 v23, v27, s98, v4 op_sel:[1,0,0,0]
    ds_read_b128 v[24:27], v13
    s_add_u32 s95, s95, 1
    s_cmp_eq_u32 s95, s54
    s_cselect_b32 s33, s55, 0xfffff000
    v_add_u32 v13, s33, v13
    ds_read_b128 v[32:35], v14
    s_add_u32 s100, s100, 1
    s_cmp_eq_u32 s100, s54
    s_cselect_b32 s33, s55, 0xfffff000
    v_add_u32 v14, s33, v14
    v_perm_b32 v36, v228, v224, s68
    v_perm_b32 v37, v236, v232, s68
    v_perm_b32 v38, v244, v240, s68
    v_perm_b32 v39, v252, v248, s68
    buffer_load_dwordx4 v[160:163], v16, s[36:39], s101 offen
    v_perm_b32 v40, v228, v224, s69
    v_perm_b32 v41, v236, v232, s69
    v_perm_b32 v42, v244, v240, s69
    v_perm_b32 v43, v252, v248, s69
    v_mfma_f32_16x16x32_bf16 v[64:67], v[36:39], v[28:31], v[64:67]
    buffer_load_dwordx4 v[164:167], v17, s[36:39], s101 offen
    v_perm_b32 v36, v229, v225, s68
    v_perm_b32 v37, v237, v233, s68
    v_perm_b32 v38, v245, v241, s68
    v_perm_b32 v39, v253, v249, s68
    v_mfma_f32_16x16x32_bf16 v[68:71], v[40:43], v[28:31], v[68:71]
    buffer_load_dwordx4 v[168:171], v18, s[36:39], s101 offen
    v_perm_b32 v40, v229, v225, s69
    v_perm_b32 v41, v237, v233, s69
    v_perm_b32 v42, v245, v241, s69
    v_perm_b32 v43, v253, v249, s69
    v_mfma_f32_16x16x32_bf16 v[72:75], v[36:39], v[28:31], v[72:75]
    buffer_load_dwordx4 v[172:175], v19, s[36:39], s101 offen
    v_perm_b32 v36, v230, v226, s68
    v_perm_b32 v37, v238, v234, s68
    v_perm_b32 v38, v246, v242, s68
    v_perm_b32 v39, v254, v250, s68
    v_mfma_f32_16x16x32_bf16 v[76:79], v[40:43], v[28:31], v[76:79]
    buffer_load_dwordx4 v[176:179], v20, s[36:39], s101 offen
    v_perm_b32 v40, v230, v226, s69
    v_perm_b32 v41, v238, v234, s69
    v_perm_b32 v42, v246, v242, s69
    v_perm_b32 v43, v254, v250, s69
    v_mfma_f32_16x16x32_bf16 v[80:83], v[36:39], v[28:31], v[80:83]
    buffer_load_dwordx4 v[180:183], v21, s[36:39], s101 offen
    v_perm_b32 v36, v231, v227, s68
    v_perm_b32 v37, v239, v235, s68
    v_perm_b32 v38, v247, v243, s68
    v_perm_b32 v39, v255, v251, s68
    v_mfma_f32_16x16x32_bf16 v[84:87], v[40:43], v[28:31], v[84:87]
    buffer_load_dwordx4 v[184:187], v22, s[36:39], s101 offen
    v_perm_b32 v40, v231, v227, s69
    v_perm_b32 v41, v239, v235, s69
    v_perm_b32 v42, v247, v243, s69
    v_perm_b32 v43, v255, v251, s69
    v_mfma_f32_16x16x32_bf16 v[88:91], v[36:39], v[28:31], v[88:91]
    buffer_load_dwordx4 v[188:191], v23, s[36:39], s101 offen
    v_mfma_f32_16x16x32_bf16 v[92:95], v[40:43], v[28:31], v[92:95]
    s_sub_u32 s94, s94, 1
    s_cbranch_scc1 L_a_36
L_a_35:
    s_sub_u32 s70, s70, 1
L_a_37:
    s_cmp_lt_u32 s70, 3
    s_waitcnt vmcnt(16) lgkmcnt(0)
    s_cbranch_scc1 L_a_38
    s_cmp_gt_u32 s95, s54
    s_cselect_b32 s101, 256, 0
    v_mad_u32_u16 v16, v24, s98, v4
    v_mad_u32_u16 v17, v24, s98, v4 op_sel:[1,0,0,0]
    v_mad_u32_u16 v18, v25, s98, v4
    v_mad_u32_u16 v19, v25, s98, v4 op_sel:[1,0,0,0]
    v_mad_u32_u16 v20, v26, s98, v4
    v_mad_u32_u16 v21, v26, s98, v4 op_sel:[1,0,0,0]
    v_mad_u32_u16 v22, v27, s98, v4
    v_mad_u32_u16 v23, v27, s98, v4 op_sel:[1,0,0,0]
    ds_read_b128 v[24:27], v13
    s_add_u32 s95, s95, 1
    s_cmp_eq_u32 s95, s54
    s_cselect_b32 s33, s55, 0xfffff000
    v_add_u32 v13, s33, v13
    ds_read_b128 v[28:31], v14
    s_add_u32 s100, s100, 1
    s_cmp_eq_u32 s100, s54
    s_cselect_b32 s33, s55, 0xfffff000
    v_add_u32 v14, s33, v14
    v_perm_b32 v36, v196, v192, s68
    v_perm_b32 v37, v204, v200, s68
    v_perm_b32 v38, v212, v208, s68
    v_perm_b32 v39, v220, v216, s68
    buffer_load_dwordx4 v[224:227], v16, s[36:39], s101 offen
    v_perm_b32 v40, v196, v192, s69
    v_perm_b32 v41, v204, v200, s69
    v_perm_b32 v42, v212, v208, s69
    v_perm_b32 v43, v220, v216, s69
    v_mfma_f32_16x16x32_bf16 v[64:67], v[36:39], v[32:35], v[64:67]
    buffer_load_dwordx4 v[228:231], v17, s[36:39], s101 offen
    v_perm_b32 v36, v197, v193, s68
    v_perm_b32 v37, v205, v201, s68
    v_perm_b32 v38, v213, v209, s68
    v_perm_b32 v39, v221, v217, s68
    v_mfma_f32_16x16x32_bf16 v[68:71], v[40:43], v[32:35], v[68:71]
    buffer_load_dwordx4 v[232:235], v18, s[36:39], s101 offen
    v_perm_b32 v40, v197, v193, s69
    v_perm_b32 v41, v205, v201, s69
    v_perm_b32 v42, v213, v209, s69
    v_perm_b32 v43, v221, v217, s69
    v_mfma_f32_16x16x32_bf16 v[72:75], v[36:39], v[32:35], v[72:75]
    buffer_load_dwordx4 v[236:239], v19, s[36:39], s101 offen
    v_perm_b32 v36, v198, v194, s68
    v_perm_b32 v37, v206, v202, s68
    v_perm_b32 v38, v214, v210, s68
    v_perm_b32 v39, v222, v218, s68
    v_mfma_f32_16x16x32_bf16 v[76:79], v[40:43], v[32:35], v[76:79]
    buffer_load_dwordx4 v[240:243], v20, s[36:39], s101 offen
    v_perm_b32 v40, v198, v194, s69
    v_perm_b32 v41, v206, v202, s69
    v_perm_b32 v42, v214, v210, s69
    v_perm_b32 v43, v222, v218, s69
    v_mfma_f32_16x16x32_bf16 v[80:83], v[36:39], v[32:35], v[80:83]
    buffer_load_dwordx4 v[244:247], v21, s[36:39], s101 offen
    v_perm_b32 v36, v199, v195, s68
    v_perm_b32 v37, v207, v203, s68
    v_perm_b32 v38, v215, v211, s68
    v_perm_b32 v39, v223, v219, s68
    v_mfma_f32_16x16x32_bf16 v[84:87], v[40:43], v[32:35], v[84:87]
    buffer_load_dwordx4 v[248:251], v22, s[36:39], s101 offen
    v_perm_b32 v40, v199, v195, s69
    v_perm_b32 v41, v207, v203, s69
    v_perm_b32 v42, v215, v211, s69
    v_perm_b32 v43, v223, v219, s69
    v_mfma_f32_16x16x32_bf16 v[88:91], v[36:39], v[32:35], v[88:91]
    buffer_load_dwordx4 v[252:255], v23, s[36:39], s101 offen
    v_mfma_f32_16x16x32_bf16 v[92:95], v[40:43], v[32:35], v[92:95]
    s_sub_u32 s94, s94, 1
    s_cbranch_scc1 L_a_41
L_a_40:
    s_sub_u32 s70, s70, 1
L_a_42:
    s_cmp_lt_u32 s70, 3
    s_waitcnt vmcnt(16) lgkmcnt(0)
    s_cbranch_scc1 L_a_43
    s_cmp_gt_u32 s95, s54
    s_cselect_b32 s101, 256, 0
    v_mad_u32_u16 v16, v24, s98, v4
    v_mad_u32_u16 v17, v24, s98, v4 op_sel:[1,0,0,0]
    v_mad_u32_u16 v18, v25, s98, v4
    v_mad_u32_u16 v19, v25, s98, v4 op_sel:[1,0,0,0]
    v_mad_u32_u16 v20, v26, s98, v4
    v_mad_u32_u16 v21, v26, s98, v4 op_sel:[1,0,0,0]
    v_mad_u32_u16 v22, v27, s98, v4
    v_mad_u32_u16 v23, v27, s98, v4 op_sel:[1,0,0,0]
    ds_read_b128 v[24:27], v13
    s_add_u32 s95, s95, 1
    s_cmp_eq_u32 s95, s54
    s_cselect_b32 s33, s55, 0xfffff000
    v_add_u32 v13, s33, v13
    ds_read_b128 v[32:35], v14
    s_add_u32 s100, s100, 1
    s_cmp_eq_u32 s100, s54
    s_cselect_b32 s33, s55, 0xfffff000
    v_add_u32 v14, s33, v14
    v_perm_b32 v36, v132, v128, s68
    v_perm_b32 v37, v140, v136, s68
    v_perm_b32 v38, v148, v144, s68
    v_perm_b32 v39, v156, v152, s68
    buffer_load_dwordx4 v[192:195], v16, s[36:39], s101 offen
    v_perm_b32 v40, v132, v128, s69
    v_perm_b32 v41, v140, v136, s69
    v_perm_b32 v42, v148, v144, s69
    v_perm_b32 v43, v156, v152, s69
    v_mfma_f32_16x16x32_bf16 v[64:67], v[36:39], v[28:31], v[64:67]
    buffer_load_dwordx4 v[196:199], v17, s[36:39], s101 offen
    v_perm_b32 v36, v133, v129, s68
    v_perm_b32 v37, v141, v137, s68
    v_perm_b32 v38, v149, v145, s68
    v_perm_b32 v39, v157, v153, s68
    v_mfma_f32_16x16x32_bf16 v[68:71], v[40:43], v[28:31], v[68:71]
    buffer_load_dwordx4 v[200:203], v18, s[36:39], s101 offen
    v_perm_b32 v40, v133, v129, s69
    v_perm_b32 v41, v141, v137, s69
    v_perm_b32 v42, v149, v145, s69
    v_perm_b32 v43, v157, v153, s69
    v_mfma_f32_16x16x32_bf16 v[72:75], v[36:39], v[28:31], v[72:75]
    buffer_load_dwordx4 v[204:207], v19, s[36:39], s101 offen
    v_perm_b32 v36, v134, v130, s68
    v_perm_b32 v37, v142, v138, s68
    v_perm_b32 v38, v150, v146, s68
    v_perm_b32 v39, v158, v154, s68
    v_mfma_f32_16x16x32_bf16 v[76:79], v[40:43], v[28:31], v[76:79]
    buffer_load_dwordx4 v[208:211], v20, s[36:39], s101 offen
    v_perm_b32 v40, v134, v130, s69
    v_perm_b32 v41, v142, v138, s69
    v_perm_b32 v42, v150, v146, s69
    v_perm_b32 v43, v158, v154, s69
    v_mfma_f32_16x16x32_bf16 v[80:83], v[36:39], v[28:31], v[80:83]
    buffer_load_dwordx4 v[212:215], v21, s[36:39], s101 offen
    v_perm_b32 v36, v135, v131, s68
    v_perm_b32 v37, v143, v139, s68
    v_perm_b32 v38, v151, v147, s68
    v_perm_b32 v39, v159, v155, s68
    v_mfma_f32_16x16x32_bf16 v[84:87], v[40:43], v[28:31], v[84:87]
    buffer_load_dwordx4 v[216:219], v22, s[36:39], s101 offen
    v_perm_b32 v40, v135, v131, s69
    v_perm_b32 v41, v143, v139, s69
    v_perm_b32 v42, v151, v147, s69
    v_perm_b32 v43, v159, v155, s69
    v_mfma_f32_16x16x32_bf16 v[88:91], v[36:39], v[28:31], v[88:91]
    buffer_load_dwordx4 v[220:223], v23, s[36:39], s101 offen
    v_mfma_f32_16x16x32_bf16 v[92:95], v[40:43], v[28:31], v[92:95]
    s_sub_u32 s94, s94, 1
    s_cbranch_scc1 L_a_46
L_a_45:
    s_sub_u32 s70, s70, 1
L_a_47:
    s_cmp_lt_u32 s70, 3
    s_waitcnt vmcnt(16) lgkmcnt(0)
    s_cbranch_scc1 L_a_48
    s_cmp_gt_u32 s95, s54
    s_cselect_b32 s101, 256, 0
    v_mad_u32_u16 v16, v24, s98, v4
    v_mad_u32_u16 v17, v24, s98, v4 op_sel:[1,0,0,0]
    v_mad_u32_u16 v18, v25, s98, v4
    v_mad_u32_u16 v19, v25, s98, v4 op_sel:[1,0,0,0]
    v_mad_u32_u16 v20, v26, s98, v4
    v_mad_u32_u16 v21, v26, s98, v4 op_sel:[1,0,0,0]
    v_mad_u32_u16 v22, v27, s98, v4
    v_mad_u32_u16 v23, v27, s98, v4 op_sel:[1,0,0,0]
    ds_read_b128 v[24:27], v13
    s_add_u32 s95, s95, 1
    s_cmp_eq_u32 s95, s54
    s_cselect_b32 s33, s55, 0xfffff000
    v_add_u32 v13, s33, v13
    ds_read_b128 v[28:31], v14
    s_add_u32 s100, s100, 1
    s_cmp_eq_u32 s100, s54
    s_cselect_b32 s33, s55, 0xfffff000
    v_add_u32 v14, s33, v14
    v_perm_b32 v36, v164, v160, s68
    v_perm_b32 v37, v172, v168, s68
    v_perm_b32 v38, v180, v176, s68
    v_perm_b32 v39, v188, v184, s68
    buffer_load_dwordx4 v[128:131], v16, s[36:39], s101 offen
    v_perm_b32 v40, v164, v160, s69
    v_perm_b32 v41, v172, v168, s69
    v_perm_b32 v42, v180, v176, s69
    v_perm_b32 v43, v188, v184, s69
    v_mfma_f32_16x16x32_bf16 v[64:67], v[36:39], v[32:35], v[64:67]
    buffer_load_dwordx4 v[132:135], v17, s[36:39], s101 offen
    v_perm_b32 v36, v165, v161, s68
    v_perm_b32 v37, v173, v169, s68
    v_perm_b32 v38, v181, v177, s68
    v_perm_b32 v39, v189, v185, s68
    v_mfma_f32_16x16x32_bf16 v[68:71], v[40:43], v[32:35], v[68:71]
    buffer_load_dwordx4 v[136:139], v18, s[36:39], s101 offen
    v_perm_b32 v40, v165, v161, s69
    v_perm_b32 v41, v173, v169, s69
    v_perm_b32 v42, v181, v177, s69
    v_perm_b32 v43, v189, v185, s69
    v_mfma_f32_16x16x32_bf16 v[72:75], v[36:39], v[32:35], v[72:75]
    buffer_load_dwordx4 v[140:143], v19, s[36:39], s101 offen
    v_perm_b32 v36, v166, v162, s68
    v_perm_b32 v37, v174, v170, s68
    v_perm_b32 v38, v182, v178, s68
    v_perm_b32 v39, v190, v186, s68
    v_mfma_f32_16x16x32_bf16 v[76:79], v[40:43], v[32:35], v[76:79]
    buffer_load_dwordx4 v[144:147], v20, s[36:39], s101 offen
    v_perm_b32 v40, v166, v162, s69
    v_perm_b32 v41, v174, v170, s69
    v_perm_b32 v42, v182, v178, s69
    v_perm_b32 v43, v190, v186, s69
    v_mfma_f32_16x16x32_bf16 v[80:83], v[36:39], v[32:35], v[80:83]
    buffer_load_dwordx4 v[148:151], v21, s[36:39], s101 offen
    v_perm_b32 v36, v167, v163, s68
    v_perm_b32 v37, v175, v171, s68
    v_perm_b32 v38, v183, v179, s68
    v_perm_b32 v39, v191, v187, s68
    v_mfma_f32_16x16x32_bf16 v[84:87], v[40:43], v[32:35], v[84:87]
    buffer_load_dwordx4 v[152:155], v22, s[36:39], s101 offen
    v_perm_b32 v40, v167, v163, s69
    v_perm_b32 v41, v175, v171, s69
    v_perm_b32 v42, v183, v179, s69
    v_perm_b32 v43, v191, v187, s69
    v_mfma_f32_16x16x32_bf16 v[88:91], v[36:39], v[32:35], v[88:91]
    buffer_load_dwordx4 v[156:159], v23, s[36:39], s101 offen
    v_mfma_f32_16x16x32_bf16 v[92:95], v[40:43], v[32:35], v[92:95]
    s_sub_u32 s94, s94, 1
    s_cbranch_scc1 L_a_51
L_a_50:
    s_sub_u32 s70, s70, 1
L_a_52:
    s_branch L_agg
L_a_36:
    s_call_b64 s[30:31], L_half
    s_branch L_a_35
L_a_33:
    s_mov_b64 exec, 1
    ds_or_b32 v2, v5 offset:76
    s_mov_b64 exec, -1
    ds_read_b128 v[32:35], v14
    s_add_u32 s100, s100, 1
    s_cmp_eq_u32 s100, s54
    s_cselect_b32 s33, s55, 0xfffff000
    v_add_u32 v14, s33, v14
    s_cmp_eq_u32 s70, 2
    s_cbranch_scc1 L_a_34
    s_cmp_eq_u32 s70, 1
    s_waitcnt vmcnt(8)
    s_cbranch_scc1 L_a_34
    s_waitcnt vmcnt(0)
L_a_34:
    v_perm_b32 v36, v228, v224, s68
    v_perm_b32 v37, v236, v232, s68
    v_perm_b32 v38, v244, v240, s68
    v_perm_b32 v39, v252, v248, s68
    v_perm_b32 v40, v228, v224, s69
    v_perm_b32 v41, v236, v232, s69
    v_perm_b32 v42, v244, v240, s69
    v_perm_b32 v43, v252, v248, s69
    v_mfma_f32_16x16x32_bf16 v[64:67], v[36:39], v[28:31], v[64:67]
    v_perm_b32 v36, v229, v225, s68
    v_perm_b32 v37, v237, v233, s68
    v_perm_b32 v38, v245, v241, s68
    v_perm_b32 v39, v253, v249, s68
    v_mfma_f32_16x16x32_bf16 v[68:71], v[40:43], v[28:31], v[68:71]
    v_perm_b32 v40, v229, v225, s69
    v_perm_b32 v41, v237, v233, s69
    v_perm_b32 v42, v245, v241, s69
    v_perm_b32 v43, v253, v249, s69
    v_mfma_f32_16x16x32_bf16 v[72:75], v[36:39], v[28:31], v[72:75]
    v_perm_b32 v36, v230, v226, s68
    v_perm_b32 v37, v238, v234, s68
    v_perm_b32 v38, v246, v242, s68
    v_perm_b32 v39, v254, v250, s68
    v_mfma_f32_16x16x32_bf16 v[76:79], v[40:43], v[28:31], v[76:79]
    v_perm_b32 v40, v230, v226, s69
    v_perm_b32 v41, v238, v234, s69
    v_perm_b32 v42, v246, v242, s69
    v_perm_b32 v43, v254, v250, s69
    v_mfma_f32_16x16x32_bf16 v[80:83], v[36:39], v[28:31], v[80:83]
    v_perm_b32 v36, v231, v227, s68
    v_perm_b32 v37, v239, v235, s68
    v_perm_b32 v38, v247, v243, s68
    v_perm_b32 v39, v255, v251, s68
    v_mfma_f32_16x16x32_bf16 v[84:87], v[40:43], v[28:31], v[84:87]
    v_perm_b32 v40, v231, v227, s69
    v_perm_b32 v41, v239, v235, s69
    v_perm_b32 v42, v247, v243, s69
    v_perm_b32 v43, v255, v251, s69
    v_mfma_f32_16x16x32_bf16 v[88:91], v[36:39], v[28:31], v[88:91]
    s_nop 0
    v_mfma_f32_16x16x32_bf16 v[92:95], v[40:43], v[28:31], v[92:95]
    s_sub_u32 s94, s94, 1
    s_cbranch_scc0 L_a_53
    s_call_b64 s[30:31], L_half
L_a_53:
    s_cmp_lg_u32 s70, 0
    s_cbranch_scc1 L_a_35
    s_branch L_round_end
L_a_41:
    s_call_b64 s[30:31], L_half
    s_branch L_a_40
L_a_38:
    s_mov_b64 exec, 1
    ds_or_b32 v2, v5 offset:76
    s_mov_b64 exec, -1
    ds_read_b128 v[28:31], v14
    s_add_u32 s100, s100, 1
    s_cmp_eq_u32 s100, s54
    s_cselect_b32 s33, s55, 0xfffff000
    v_add_u32 v14, s33, v14
    s_cmp_eq_u32 s70, 2
    s_cbranch_scc1 L_a_39
    s_cmp_eq_u32 s70, 1
    s_waitcnt vmcnt(8)
    s_cbranch_scc1 L_a_39
    s_waitcnt vmcnt(0)
L_a_39:
    v_perm_b32 v36, v196, v192, s68
    v_perm_b32 v37, v204, v200, s68
    v_perm_b32 v38, v212, v208, s68
    v_perm_b32 v39, v220, v216, s68
    v_perm_b32 v40, v196, v192, s69
    v_perm_b32 v41, v204, v200, s69
    v_perm_b32 v42, v212, v208, s69
    v_perm_b32 v43, v220, v216, s69
    v_mfma_f32_16x16x32_bf16 v[64:67], v[36:39], v[32:35], v[64:67]
    v_perm_b32 v36, v197, v193, s68
    v_perm_b32 v37, v205, v201, s68
    v_perm_b32 v38, v213, v209, s68
    v_perm_b32 v39, v221, v217, s68
    v_mfma_f32_16x16x32_bf16 v[68:71], v[40:43], v[32:35], v[68:71]
    v_perm_b32 v40, v197, v193, s69
    v_perm_b32 v41, v205, v201, s69
    v_perm_b32 v42, v213, v209, s69
    v_perm_b32 v43, v221, v217, s69
    v_mfma_f32_16x16x32_bf16 v[72:75], v[36:39], v[32:35], v[72:75]
    v_perm_b32 v36, v198, v194, s68
    v_perm_b32 v37, v206, v202, s68
    v_perm_b32 v38, v214, v210, s68
    v_perm_b32 v39, v222, v218, s68
    v_mfma_f32_16x16x32_bf16 v[76:79], v[40:43], v[32:35], v[76:79]
    v_perm_b32 v40, v198, v194, s69
    v_perm_b32 v41, v206, v202, s69
    v_perm_b32 v42, v214, v210, s69
    v_perm_b32 v43, v222, v218, s69
    v_mfma_f32_16x16x32_bf16 v[80:83], v[36:39], v[32:35], v[80:83]
    v_perm_b32 v36, v199, v195, s68
    v_perm_b32 v37, v207, v203, s68
    v_perm_b32 v38, v215, v211, s68
    v_perm_b32 v39, v223, v219, s68
    v_mfma_f32_16x16x32_bf16 v[84:87], v[40:43], v[32:35], v[84:87]
    v_perm_b32 v40, v199, v195, s69
    v_perm_b32 v41, v207, v203, s69
    v_perm_b32 v42, v215, v211, s69
    v_perm_b32 v43, v223, v219, s69
    v_mfma_f32_16x16x32_bf16 v[88:91], v[36:39], v[32:35], v[88:91]
    s_nop 0
    v_mfma_f32_16x16x32_bf16 v[92:95], v[40:43], v[32:35], v[92:95]
    s_sub_u32 s94, s94, 1
    s_cbranch_scc0 L_a_54
    s_call_b64 s[30:31], L_half
L_a_54:
    s_cmp_lg_u32 s70, 0
    s_cbranch_scc1 L_a_40
    s_branch L_round_end
L_a_46:
    s_call_b64 s[30:31], L_half
    s_branch L_a_45
L_a_43:
    s_mov_b64 exec, 1
    ds_or_b32 v2, v5 offset:76
    s_mov_b64 exec, -1
    ds_read_b128 v[32:35], v14
    s_add_u32 s100, s100, 1
    s_cmp_eq_u32 s100, s54
    s_cselect_b32 s33, s55, 0xfffff000
    v_add_u32 v14, s33, v14
    s_cmp_eq_u32 s70, 2
    s_cbranch_scc1 L_a_44
    s_cmp_eq_u32 s70, 1
    s_waitcnt vmcnt(8)
    s_cbranch_scc1 L_a_44
    s_waitcnt vmcnt(0)
L_a_44:
    v_perm_b32 v36, v132, v128, s68
    v_perm_b32 v37, v140, v136, s68
    v_perm_b32 v38, v148, v144, s68
    v_perm_b32 v39, v156, v152, s68
    v_perm_b32 v40, v132, v128, s69
    v_perm_b32 v41, v140, v136, s69
    v_perm_b32 v42, v148, v144, s69
    v_perm_b32 v43, v156, v152, s69
    v_mfma_f32_16x16x32_bf16 v[64:67], v[36:39], v[28:31], v[64:67]
    v_perm_b32 v36, v133, v129, s68
    v_perm_b32 v37, v141, v137, s68
    v_perm_b32 v38, v149, v145, s68
    v_perm_b32 v39, v157, v153, s68
    v_mfma_f32_16x16x32_bf16 v[68:71], v[40:43], v[28:31], v[68:71]
    v_perm_b32 v40, v133, v129, s69
    v_perm_b32 v41, v141, v137, s69
    v_perm_b32 v42, v149, v145, s69
    v_perm_b32 v43, v157, v153, s69
    v_mfma_f32_16x16x32_bf16 v[72:75], v[36:39], v[28:31], v[72:75]
    v_perm_b32 v36, v134, v130, s68
    v_perm_b32 v37, v142, v138, s68
    v_perm_b32 v38, v150, v146, s68
    v_perm_b32 v39, v158, v154, s68
    v_mfma_f32_16x16x32_bf16 v[76:79], v[40:43], v[28:31], v[76:79]
    v_perm_b32 v40, v134, v130, s69
    v_perm_b32 v41, v142, v138, s69
    v_perm_b32 v42, v150, v146, s69
    v_perm_b32 v43, v158, v154, s69
    v_mfma_f32_16x16x32_bf16 v[80:83], v[36:39], v[28:31], v[80:83]
    v_perm_b32 v36, v135, v131, s68
    v_perm_b32 v37, v143, v139, s68
    v_perm_b32 v38, v151, v147, s68
    v_perm_b32 v39, v159, v155, s68
    v_mfma_f32_16x16x32_bf16 v[84:87], v[40:43], v[28:31], v[84:87]
    v_perm_b32 v40, v135, v131, s69
    v_perm_b32 v41, v143, v139, s69
    v_perm_b32 v42, v151, v147, s69
    v_perm_b32 v43, v159, v155, s69
    v_mfma_f32_16x16x32_bf16 v[88:91], v[36:39], v[28:31], v[88:91]
    s_nop 0
    v_mfma_f32_16x16x32_bf16 v[92:95], v[40:43], v[28:31], v[92:95]
    s_sub_u32 s94, s94, 1
    s_cbranch_scc0 L_a_55
    s_call_b64 s[30:31], L_half
L_a_55:
    s_cmp_lg_u32 s70, 0
    s_cbranch_scc1 L_a_45
    s_branch L_round_end
L_a_51:
    s_call_b64 s[30:31], L_half
    s_branch L_a_50
L_a_48:
    s_mov_b64 exec, 1
    ds_or_b32 v2, v5 offset:76
    s_mov_b64 exec, -1
    ds_read_b128 v[28:31], v14
    s_add_u32 s100, s100, 1
    s_cmp_eq_u32 s100, s54
    s_cselect_b32 s33, s55, 0xfffff000
    v_add_u32 v14, s33, v14
    s_cmp_eq_u32 s70, 2
    s_cbranch_scc1 L_a_49
    s_cmp_eq_u32 s70, 1
    s_waitcnt vmcnt(8)
    s_cbranch_scc1 L_a_49
    s_waitcnt vmcnt(0)
L_a_49:
    v_perm_b32 v36, v164, v160, s68
    v_perm_b32 v37, v172, v168, s68
    v_perm_b32 v38, v180, v176, s68
    v_perm_b32 v39, v188, v184, s68
    v_perm_b32 v40, v164, v160, s69
    v_perm_b32 v41, v172, v168, s69
    v_perm_b32 v42, v180, v176, s69
    v_perm_b32 v43, v188, v184, s69
    v_mfma_f32_16x16x32_bf16 v[64:67], v[36:39], v[32:35], v[64:67]
    v_perm_b32 v36, v165, v161, s68
    v_perm_b32 v37, v173, v169, s68
    v_perm_b32 v38, v181, v177, s68
    v_perm_b32 v39, v189, v185, s68
    v_mfma_f32_16x16x32_bf16 v[68:71], v[40:43], v[32:35], v[68:71]
    v_perm_b32 v40, v165, v161, s69
    v_perm_b32 v41, v173, v169, s69
    v_perm_b32 v42, v181, v177, s69
    v_perm_b32 v43, v189, v185, s69
    v_mfma_f32_16x16x32_bf16 v[72:75], v[36:39], v[32:35], v[72:75]
    v_perm_b32 v36, v166, v162, s68
    v_perm_b32 v37, v174, v170, s68
    v_perm_b32 v38, v182, v178, s68
    v_perm_b32 v39, v190, v186, s68
    v_mfma_f32_16x16x32_bf16 v[76:79], v[40:43], v[32:35], v[76:79]
    v_perm_b32 v40, v166, v162, s69
    v_perm_b32 v41, v174, v170, s69
    v_perm_b32 v42, v182, v178, s69
    v_perm_b32 v43, v190, v186, s69
    v_mfma_f32_16x16x32_bf16 v[80:83], v[36:39], v[32:35], v[80:83]
    v_perm_b32 v36, v167, v163, s68
    v_perm_b32 v37, v175, v171, s68
    v_perm_b32 v38, v183, v179, s68
    v_perm_b32 v39, v191, v187, s68
    v_mfma_f32_16x16x32_bf16 v[84:87], v[40:43], v[32:35], v[84:87]
    v_perm_b32 v40, v167, v163, s69
    v_perm_b32 v41, v175, v171, s69
    v_perm_b32 v42, v183, v179, s69
    v_perm_b32 v43, v191, v187, s69
    v_mfma_f32_16x16x32_bf16 v[88:91], v[36:39], v[32:35], v[88:91]
    s_nop 0
    v_mfma_f32_16x16x32_bf16 v[92:95], v[40:43], v[32:35], v[92:95]
    s_sub_u32 s94, s94, 1
    s_cbranch_scc0 L_a_56
    s_call_b64 s[30:31], L_half
L_a_56:
    s_cmp_lg_u32 s70, 0
    s_cbranch_scc1 L_a_50
    s_branch L_round_end
L_round_end:
    s_cmp_lg_u32 s67, 0
    s_cbranch_scc1 L_slow_swap
L_A_tail:
    s_mov_b64 exec, 1
    ds_or_b32 v2, v5 offset:76
    s_mov_b64 exec, -1
    s_call_b64 s[30:31], L_wout
    s_mov_b64 exec, 1
    ds_add_u32 v2, v3 offset:16
    s_mov_b64 exec, -1
    s_branch L_A_done
L_half:
    s_cmp_lg_u32 s67, 0
    s_cbranch_scc1 L_swap
    s_mov_b64 s[96:97], s[30:31]
L_half_out:
L_sw_57:
    ds_read_b32 v62, v2 offset:64
    s_waitcnt lgkmcnt(0)
    v_readfirstlane_b32 s33, v62
    s_cmp_ge_u32 s33, 4
    s_cbranch_scc1 L_sd_58
    s_add_u32 s93, s93, 1
    s_cmp_lt_u32 s93, 2097152
    s_cbranch_scc1 L_sw_57
    s_endpgm
L_sd_58:
    v_lshlrev_b32 v12, 16, v12
    s_call_b64 s[30:31], L_wout
    s_mov_b64 exec, 1
    ds_add_u32 v2, v3 offset:68
    s_mov_b64 exec, -1
    v_add_u32 v11, 10240, v11
    v_mov_b32 v64, v96
    v_mov_b32 v65, v97
    v_mov_b32 v66, v98
    v_mov_b32 v67, v99
    v_mov_b32 v68, v100
    v_mov_b32 v69, v101
    v_mov_b32 v70, v102
    v_mov_b32 v71, v103
    v_mov_b32 v72, v104
    v_mov_b32 v73, v105
    v_mov_b32 v74, v106
    v_mov_b32 v75, v107
    v_mov_b32 v76, v108
    v_mov_b32 v77, v109
    v_mov_b32 v78, v110
    v_mov_b32 v79, v111
    v_mov_b32 v80, v112
    v_mov_b32 v81, v113
    v_mov_b32 v82, v114
    v_mov_b32 v83, v115
    v_mov_b32 v84, v116
    v_mov_b32 v85, v117
    v_mov_b32 v86, v118
    v_mov_b32 v87, v119
    v_mov_b32 v88, v120
    v_mov_b32 v89, v121
    v_mov_b32 v90, v122
    v_mov_b32 v91, v123
    v_mov_b32 v92, v124
    v_mov_b32 v93, v125
    v_mov_b32 v94, v126
    v_mov_b32 v95, v127
    s_setpc_b64 s[96:97]
L_swap:
    s_nop 7
    v_swap_b32 v64, v96
    v_swap_b32 v65, v97
    v_swap_b32 v66, v98
    v_swap_b32 v67, v99
    v_swap_b32 v68, v100
    v_swap_b32 v69, v101
    v_swap_b32 v70, v102
    v_swap_b32 v71, v103
    v_swap_b32 v72, v104
    v_swap_b32 v73, v105
    v_swap_b32 v74, v106
    v_swap_b32 v75, v107
    v_swap_b32 v76, v108
    v_swap_b32 v77, v109
    v_swap_b32 v78, v110
    v_swap_b32 v79, v111
    v_swap_b32 v80, v112
    v_swap_b32 v81, v113
    v_swap_b32 v82, v114
    v_swap_b32 v83, v115
    v_swap_b32 v84, v116
    v_swap_b32 v85, v117
    v_swap_b32 v86, v118
    v_swap_b32 v87, v119
    v_swap_b32 v88, v120
    v_swap_b32 v89, v121
    v_swap_b32 v90, v122
    v_swap_b32 v91, v123
    v_swap_b32 v92, v124
    v_swap_b32 v93, v125
    v_swap_b32 v94, v126
    v_swap_b32 v95, v127
    s_setpc_b64 s[30:31]
L_empty:
    s_cmp_lg_u32 s67, 0
    s_cbranch_scc1 L_slow_next
    v_mov_b32 v64, 0
    v_mov_b32 v65, 0
    v_mov_b32 v66, 0
    v_mov_b32 v67, 0
    v_mov_b32 v68, 0
    v_mov_b32 v69, 0
    v_mov_b32 v70, 0
    v_mov_b32 v71, 0
    v_mov_b32 v72, 0
    v_mov_b32 v73, 0
    v_mov_b32 v74, 0
    v_mov_b32 v75, 0
    v_mov_b32 v76, 0
    v_mov_b32 v77, 0
    v_mov_b32 v78, 0
    v_mov_b32 v79, 0
    v_mov_b32 v80, 0
    v_mov_b32 v81, 0
    v_mov_b32 v82, 0
    v_mov_b32 v83, 0
    v_mov_b32 v84, 0
    v_mov_b32 v85, 0
    v_mov_b32 v86, 0
    v_mov_b32 v87, 0
    v_mov_b32 v88, 0
    v_mov_b32 v89, 0
    v_mov_b32 v90, 0
    v_mov_b32 v91, 0
    v_mov_b32 v92, 0
    v_mov_b32 v93, 0
    v_mov_b32 v94, 0
    v_mov_b32 v95, 0
    v_mov_b32 v96, 0
    v_mov_b32 v97, 0
    v_mov_b32 v98, 0
    v_mov_b32 v99, 0
    v_mov_b32 v100, 0
    v_mov_b32 v101, 0
    v_mov_b32 v102, 0
    v_mov_b32 v103, 0
    v_mov_b32 v104, 0
    v_mov_b32 v105, 0
    v_mov_b32 v106, 0
    v_mov_b32 v107, 0
    v_mov_b32 v108, 0
    v_mov_b32 v109, 0
    v_mov_b32 v110, 0
    v_mov_b32 v111, 0
    v_mov_b32 v112, 0
    v_mov_b32 v113, 0
    v_mov_b32 v114, 0
    v_mov_b32 v115, 0
    v_mov_b32 v116, 0
    v_mov_b32 v117, 0
    v_mov_b32 v118, 0
    v_mov_b32 v119, 0
    v_mov_b32 v120, 0
    v_mov_b32 v121, 0
    v_mov_b32 v122, 0
    v_mov_b32 v123, 0
    v_mov_b32 v124, 0
    v_mov_b32 v125, 0
    v_mov_b32 v126, 0
    v_mov_b32 v127, 0
    s_call_b64 s[30:31], L_half
    s_branch L_A_tail
L_slow_swap:
    s_call_b64 s[30:31], L_swap
    s_branch L_slow_next
L_slow_done:
    s_call_b64 s[96:97], L_half_out
    s_branch L_A_tail
L_slow_enter:
    v_mov_b32 v64, 0
    v_mov_b32 v65, 0
    v_mov_b32 v66, 0
    v_mov_b32 v67, 0
    v_mov_b32 v68, 0
    v_mov_b32 v69, 0
    v_mov_b32 v70, 0
    v_mov_b32 v71, 0
    v_mov_b32 v72, 0
    v_mov_b32 v73, 0
    v_mov_b32 v74, 0
    v_mov_b32 v75, 0
    v_mov_b32 v76, 0
    v_mov_b32 v77, 0
    v_mov_b32 v78, 0
    v_mov_b32 v79, 0
    v_mov_b32 v80, 0
    v_mov_b32 v81, 0
    v_mov_b32 v82, 0
    v_mov_b32 v83, 0
    v_mov_b32 v84, 0
    v_mov_b32 v85, 0
    v_mov_b32 v86, 0
    v_mov_b32 v87, 0
    v_mov_b32 v88, 0
    v_mov_b32 v89, 0
    v_mov_b32 v90, 0
    v_mov_b32 v91, 0
    v_mov_b32 v92, 0
    v_mov_b32 v93, 0
    v_mov_b32 v94, 0
    v_mov_b32 v95, 0
    v_mov_b32 v96, 0
    v_mov_b32 v97, 0
    v_mov_b32 v98, 0
    v_mov_b32 v99, 0
    v_mov_b32 v100, 0
    v_mov_b32 v101, 0
    v_mov_b32 v102, 0
    v_mov_b32 v103, 0
    v_mov_b32 v104, 0
    v_mov_b32 v105, 0
    v_mov_b32 v106, 0
    v_mov_b32 v107, 0
    v_mov_b32 v108, 0
    v_mov_b32 v109, 0
    v_mov_b32 v110, 0
    v_mov_b32 v111, 0
    v_mov_b32 v112, 0
    v_mov_b32 v113, 0
    v_mov_b32 v114, 0
    v_mov_b32 v115, 0
    v_mov_b32 v116, 0
    v_mov_b32 v117, 0
    v_mov_b32 v118, 0
    v_mov_b32 v119, 0
    v_mov_b32 v120, 0
    v_mov_b32 v121, 0
    v_mov_b32 v122, 0
    v_mov_b32 v123, 0
    v_mov_b32 v124, 0
    v_mov_b32 v125, 0
    v_mov_b32 v126, 0
    v_mov_b32 v127, 0
L_slow_next:
    s_mov_b32 s44, s6
    s_mov_b32 s45, s7
    s_mov_b32 s46, 640000
    s_mov_b32 s47, 0x20000
    s_mov_b32 s48, s8
    s_mov_b32 s49, s9
    s_mov_b32 s50, 640000
    s_mov_b32 s51, 0x20000
    s_cmp_eq_u32 s67, 640
    s_cbranch_scc1 L_slow_done
    s_mul_i32 s33, s67, 1000
    s_add_u32 s67, s67, 1
    v_lshl_add_u32 v62, s32, 6, v1
    v_cmp_gt_u32 vcc, 250, v62
    s_mov_b64 s[96:97], vcc
    v_lshlrev_b32 v62, 2, v62
    buffer_load_dword v44, v62, s[44:47], s33 offen
    buffer_load_dword v45, v62, s[48:51], s33 offen
    v_lshrrev_b32 v62, 4, v1
    s_lshl_b32 s33, s32, 8
    s_add_u32 s33, s33, 131072
    v_lshl_add_u32 v14, v62, 10, v4
    v_add_u32 v14, s33, v14
    v_or_b32 v13, 240, v14
    s_waitcnt lgkmcnt(0)
    s_call_b64 s[30:31], L_init
    s_add_u32 s52, s52, 4
    s_mov_b64 exec, 1
    ds_add_u32 v2, v3 offset:48
    s_mov_b64 exec, -1
L_sw_59:
    ds_read_b32 v62, v2 offset:48
    s_waitcnt lgkmcnt(0)
    v_readfirstlane_b32 s33, v62
    s_cmp_ge_u32 s33, s52
    s_cbranch_scc1 L_sd_60
    s_add_u32 s93, s93, 1
    s_cmp_lt_u32 s93, 2097152
    s_cbranch_scc1 L_sw_59
    s_endpgm
L_sd_60:
    s_waitcnt vmcnt(0)
    v_subrev_u32 v45, s12, v45
    v_cmp_gt_u32 vcc, s13, v45
    s_and_b64 vcc, vcc, s[96:97]
    v_mul_u32_u24 v62, 26, v45
    v_lshrrev_b32 v62, 8, v62
    v_mad_u32_u24 v62, v62, 6, v45
    v_lshl_or_b32 v62, v62, 14, v44
    v_mov_b32 v45, 1032192
    v_cndmask_b32_e64 v44, v45, v62, vcc
    v_mov_b32 v46, 1032192
    v_mov_b32 v47, 1032192
    v_mov_b32 v48, 1032192
    v_mov_b32 v49, 1032192
    v_mov_b32 v50, 1032192
    v_mov_b32 v51, 1032192
    s_mov_b32 s35, 0
    s_branch L_round
L_init:
    v_and_b32 v62, 15, v1
    v_cmp_eq_u32 vcc, 15, v62
    s_and_b32 s33, s71, 4
    s_lshl_b32 s33, s33, 1
    v_mov_b32 v63, s33
    v_cndmask_b32_e64 v28, 0, -1, vcc
    v_cndmask_b32_e64 v29, 0, -1, vcc
    v_cndmask_b32_e64 v30, 0, -1, vcc
    v_cndmask_b32_e64 v31, 0, -1, vcc
    ds_write_b32 v63, v2 offset:32
    ds_write_b32 v63, v2 offset:36
    ds_write_b128 v14, v[28:31] offset:0
    ds_write_b128 v14, v[28:31] offset:4096
    ds_write_b128 v14, v[28:31] offset:8192
    ds_write_b128 v14, v[28:31] offset:12288
    ds_write_b128 v14, v[28:31] offset:16384
    ds_write_b128 v14, v[28:31] offset:20480
    ds_write_b128 v14, v[28:31] offset:24576
    ds_write_b128 v14, v[28:31] offset:28672
    s_setpc_b64 s[30:31]
L_wout:
    s_nop 7
    s_mov_b32 exec_lo, 0x03ff03ff
    s_mov_b32 exec_hi, 0x03ff03ff
    v_pk_mul_f32 v[64:65], v[64:65], v[12:13] op_sel_hi:[1,0]
    v_pk_mul_f32 v[66:67], v[66:67], v[12:13] op_sel_hi:[1,0]
    v_pk_mul_f32 v[68:69], v[68:69], v[12:13] op_sel_hi:[1,0]
    v_pk_mul_f32 v[70:71], v[70:71], v[12:13] op_sel_hi:[1,0]
    v_pk_mul_f32 v[72:73], v[72:73], v[12:13] op_sel_hi:[1,0]
    v_pk_mul_f32 v[74:75], v[74:75], v[12:13] op_sel_hi:[1,0]
    v_pk_mul_f32 v[76:77], v[76:77], v[12:13] op_sel_hi:[1,0]
    v_pk_mul_f32 v[78:79], v[78:79], v[12:13] op_sel_hi:[1,0]
    v_pk_mul_f32 v[80:81], v[80:81], v[12:13] op_sel_hi:[1,0]
    v_pk_mul_f32 v[82:83], v[82:83], v[12:13] op_sel_hi:[1,0]
    v_pk_mul_f32 v[84:85], v[84:85], v[12:13] op_sel_hi:[1,0]
    v_pk_mul_f32 v[86:87], v[86:87], v[12:13] op_sel_hi:[1,0]
    v_pk_mul_f32 v[88:89], v[88:89], v[12:13] op_sel_hi:[1,0]
    v_pk_mul_f32 v[90:91], v[90:91], v[12:13] op_sel_hi:[1,0]
    v_pk_mul_f32 v[92:93], v[92:93], v[12:13] op_sel_hi:[1,0]
    v_pk_mul_f32 v[94:95], v[94:95], v[12:13] op_sel_hi:[1,0]
    v_cvt_pk_bf16_f32 v36, v64, v68
    v_cvt_pk_bf16_f32 v37, v72, v76
    v_cvt_pk_bf16_f32 v38, v80, v84
    v_cvt_pk_bf16_f32 v39, v88, v92
    ds_write_b128 v11, v[36:39] offset:0
    v_cvt_pk_bf16_f32 v40, v65, v69
    v_cvt_pk_bf16_f32 v41, v73, v77
    v_cvt_pk_bf16_f32 v42, v81, v85
    v_cvt_pk_bf16_f32 v43, v89, v93
    ds_write_b128 v11, v[40:43] offset:2560
    v_cvt_pk_bf16_f32 v36, v66, v70
    v_cvt_pk_bf16_f32 v37, v74, v78
    v_cvt_pk_bf16_f32 v38, v82, v86
    v_cvt_pk_bf16_f32 v39, v90, v94
    ds_write_b128 v11, v[36:39] offset:5120
    v_cvt_pk_bf16_f32 v40, v67, v71
    v_cvt_pk_bf16_f32 v41, v75, v79
    v_cvt_pk_bf16_f32 v42, v83, v87
    v_cvt_pk_bf16_f32 v43, v91, v95
    ds_write_b128 v11, v[40:43] offset:7680
    s_mov_b64 exec, -1
    s_setpc_b64 s[30:31]
L_A_done:
    s_endpgm
L_upd:
    s_cmp_lg_u32 s3, 0
    s_cbranch_scc1 L_end
    s_waitcnt lgkmcnt(0)
    global_load_dword v15, v2, s[28:29] sc1
    s_add_u32 s60, s28, 1024
    s_addc_u32 s61, s29, 0
    s_mov_b32 s62, 1000
    s_mov_b32 s63, 0x20000
    s_waitcnt vmcnt(0)
    v_readfirstlane_b32 s64, v15
    s_lshr_b32 s64, s64, 20
    s_add_u32 s65, s64, 709
    s_lshl_b32 s65, s65, 20
    s_or_b32 s66, s65, 370085
    s_mov_b32 s70, -1
    s_mov_b32 s71, 67108863
L_upd_poll:
    s_sleep 16
    buffer_load_dword v16, v4, s[60:63], 0 offen offset:0 sc1
    buffer_load_dword v17, v4, s[60:63], 0 offen offset:256 sc1
    buffer_load_dword v18, v4, s[60:63], 0 offen offset:512 sc1
    buffer_load_dword v19, v4, s[60:63], 0 offen offset:768 sc1
    s_waitcnt vmcnt(0)
    v_cmp_ne_u32 s[72:73], s66, v16
    v_cmp_ne_u32 s[74:75], s66, v17
    v_cmp_ne_u32 s[76:77], s66, v18
    v_cmp_ne_u32 s[78:79], s66, v19
    s_or_b64 s[72:73], s[72:73], s[74:75]
    s_and_b64 s[78:79], s[78:79], s[70:71]
    s_or_b64 s[72:73], s[72:73], s[76:77]
    s_or_b64 s[72:73], s[72:73], s[78:79]
    s_cbranch_scc0 L_upd_go
    s_add_u32 s93, s93, 32
    s_cmp_ge_u32 s93, 2097152
    s_cbranch_scc0 L_upd_poll
    s_endpgm
L_upd_go:
    v_mov_b32 v6, s65
    s_mov_b64 exec, 1
    global_store_dword v2, v6, s[28:29] sc0 sc1
L_end:
    s_endpgm
.section .rodata,"a"
.p2align 6
.amdhsa_kernel gather_scatter__hybrid_graph_tf_exphormer__graph_kernel
  .amdhsa_next_free_vgpr 256
  .amdhsa_next_free_sgpr 102
  .amdhsa_accum_offset 256
  .amdhsa_group_segment_fixed_size 0
  .amdhsa_kernarg_size 104
  .amdhsa_user_sgpr_count 2
  .amdhsa_user_sgpr_kernarg_segment_ptr 1
  .amdhsa_system_sgpr_workgroup_id_x 1
  .amdhsa_float_denorm_mode_32 3
.end_amdhsa_kernel
```
